```python
import torch

def _softmax(x, axis=-1):
    return torch.softmax(x, dim=axis)
def _gelu(x):
    return torch.nn.functional.gelu(x, approximate="tanh")
def _silu(x):
    return torch.nn.functional.silu(x)
def _sigmoid(x):
    return torch.sigmoid(x)
def _layernorm(x, axis=-1, eps=1e-5):
    m = x.mean(dim=axis, keepdim=True)
    v = x.var(dim=axis, keepdim=True, unbiased=False)
    return (x - m) / torch.sqrt(v + eps)
def _scatter_add(tgt, idx, src, axis=0):
    return tgt.clone().index_add_(axis, idx, src)
def _segment_sum(src, seg, n):
    out = torch.zeros((n,) + src.shape[1:], dtype=src.dtype)
    return out.index_add_(0, seg, src)
def _pad(x, pw):
    flat = tuple(v for pair in reversed(pw) for v in pair)
    return torch.nn.functional.pad(x, flat)

kernel_name = 'concat_heads__sliding_block__sliding_local_dilated__prompt'

def setup_inputs():

    _w = (lambda a: (lambda t: t.to(torch.bfloat16) if t.is_floating_point() else t)(torch.as_tensor(a)))
    def _A_setup():
        B, S, D = 1, 2048, 448
        return {
            "x": _w((lambda *s: torch.randn(*s, dtype=torch.bfloat16) * 0.2)(B, S, D)),
            "wqkv": _w((lambda *s: torch.randn(*s, dtype=torch.bfloat16) * 0.4)(D, 3 * D)),
            "wo": _w((lambda *s: torch.randn(*s, dtype=torch.bfloat16) * 0.4)(D, D)),
        }
    _A_in = _A_setup()

    def _B_setup():
        B, S, D = 1, 2048, 448
        return {
            "x": _w((lambda *s: torch.randn(*s, dtype=torch.bfloat16) * 0.2)(B, S, D)),
            "wqkv": _w((lambda *s: torch.randn(*s, dtype=torch.bfloat16) * 0.4)(D, 3 * D)),
            "wo": _w((lambda *s: torch.randn(*s, dtype=torch.bfloat16) * 0.4)(D, D)),
        }
    _B_in = _B_setup()

    return {
        "A_x": _A_in["x"],
        "A_wqkv": _A_in["wqkv"],
        "A_wo": _A_in["wo"],
        "B_x": _B_in["x"],
        "B_wqkv": _B_in["wqkv"],
        "B_wo": _B_in["wo"],
    }

def reference(A_x, A_wqkv, A_wo, B_x, B_wqkv, B_wo):
    def _A_ref(x, wqkv, wo):
        B, S, D = x.shape
        H = 16; Dh = D // H; W = 256
        qkv = (lambda x, *d: x.permute(*d))((x @ wqkv).reshape(B, S, 3, H, Dh), 2, 0, 3, 1, 4)
        q, k, v = qkv[0], qkv[1], qkv[2]
        scores = torch.einsum("bhqd,bhkd->bhqk", q, k) * (Dh ** -0.5)
        idx = torch.arange(S)
        mask = (idx[:, None] - idx[None, :] >= 0) & (idx[:, None] - idx[None, :] < W)
        scores = torch.where(mask[None, None], scores, -1e9)
        p = _softmax(scores, axis=-1)
        o = torch.einsum("bhqk,bhkd->bhqd", p, v)
        return (lambda x, *d: x.permute(*d))(o, 0, 2, 1, 3).reshape(B, S, D) @ wo

    def _B_ref(x, wqkv, wo):
        B, S, D = x.shape
        H = 16; Dh = D // H
        W, dil = 8, 2
        qkv = (lambda x, *d: x.permute(*d))((x @ wqkv).reshape(B, S, 3, H, Dh), 2, 0, 3, 1, 4)
        q, k, v = qkv[0], qkv[1], qkv[2]
        scale = Dh ** -0.5
        pos = torch.arange(S)
        off = torch.arange(W) * dil
        idx = pos[:, None] - off[None, :]
        mask = idx >= 0
        idx_c = torch.where(mask, idx, 0).reshape(-1)
        kg = k[:, :, idx_c, :].reshape(B, H, S, W, Dh)
        vg = v[:, :, idx_c, :].reshape(B, H, S, W, Dh)
        logits = torch.einsum("bhsd,bhswd->bhsw", q, kg) * scale
        logits = torch.where(mask[None, None, :, :], logits, -1e9)
        attn = _softmax(logits, axis=-1)
        o = torch.einsum("bhsw,bhswd->bhsd", attn, vg)
        return (lambda x, *d: x.permute(*d))(o, 0, 2, 1, 3).reshape(B, S, D) @ wo

    a = _A_ref(A_x, A_wqkv, A_wo)
    b = _B_ref(B_x, B_wqkv, B_wo)
    return torch.concatenate([a, b], axis=-1)
```

```asm
; @launch grid=(256,1,1) block=(512,1,1) lds=163840
.amdgcn_target "amdgcn-amd-amdhsa--gfx950"
.text
.globl concat_heads__sliding_block__sliding_local_dilated__prompt_kernel
.p2align 8
.type concat_heads__sliding_block__sliding_local_dilated__prompt_kernel,@function
concat_heads__sliding_block__sliding_local_dilated__prompt_kernel:
    s_cmp_ge_u32 s2, 256
    s_cbranch_scc1 L_end
    s_load_dwordx16 s[16:31], s[0:1], 0
    s_load_dwordx2 s[32:33], s[0:1], 64
    v_lshrrev_b32 v1, 6, v0
    v_and_b32 v255, 63, v0
    v_readfirstlane_b32 s4, v1
    s_and_b32 s13, s2, 7
    s_lshr_b32 s14, s2, 3
    s_lshr_b32 s5, s13, 2
    s_xor_b32 s5, s5, 1
    s_and_b32 s15, s13, 1
    s_lshl_b32 s15, s15, 2
    s_lshr_b32 s3, s14, 3
    s_add_u32 s6, s15, s3
    s_and_b32 s15, s13, 2
    s_lshl_b32 s15, s15, 2
    s_and_b32 s3, s14, 7
    s_add_u32 s7, s15, s3
    v_lshlrev_b32 v254, 4, v255
    v_lshrrev_b32 v1, 3, v255
    v_and_b32 v2, 7, v255
    v_lshrrev_b32 v3, 4, v255
    s_cmp_lg_u32 s5, 0
    s_cbranch_scc1 L_brB
    s_cmp_lt_u32 s4, 4
    s_cbranch_scc1 L_compute
    s_sub_u32 s96, s4, 4
    s_lshl_b32 s34, s7, 7
    s_lshl_b32 s35, s96, 5
    s_add_u32 s34, s34, s35
    v_add_u32 v4, s34, v1
    v_mul_u32_u24 v4, 896, v4
    v_xor_b32 v5, v2, v3
    v_lshl_add_u32 v10, v5, 4, v4
    v_xor_b32 v5, 4, v5
    v_lshl_add_u32 v11, v5, 4, v4
    v_add_u32 v11, 6144, v11
    s_lshl_b32 s97, s96, 12
    s_lshl_b32 s101, s96, 11
    s_lshl_b32 s35, s96, 4
    v_add_u32 v4, s35, v1
    v_mul_u32_u24 v4, 2688, v4
    s_lshl_b32 s35, s6, 7
    v_add_u32 v4, s35, v4
    v_and_b32 v5, 1, v3
    v_lshlrev_b32 v5, 2, v5
    v_xor_b32 v5, v2, v5
    v_lshl_add_u32 v13, v5, 4, v4
    v_add_u32 v14, 20480, v13
    s_mov_b32 s38, 1835008
    s_mov_b32 s39, 0x20000
    s_mov_b32 s42, 1204224
    s_mov_b32 s43, 0x20000
    s_waitcnt lgkmcnt(0)
    s_mov_b32 s36, s16
    s_mov_b32 s37, s17
    s_mov_b32 s40, s18
    s_mov_b32 s41, s19
    s_cmp_eq_u32 s6, 7
    s_cbranch_scc1 L_ld_idle
    s_add_u32 m0, s97, 40960
    s_mov_b32 s34, 0
    s_mov_b32 s35, 12288
    buffer_load_dwordx4 v10, s[36:39], s34 offen lds
    buffer_load_dwordx4 v11, s[36:39], s34 offen offset:1024 lds
    buffer_load_dwordx4 v10, s[36:39], s35 offen offset:2048 lds
    buffer_load_dwordx4 v11, s[36:39], s35 offen offset:3072 lds
    s_add_u32 m0, s101, 65536
    s_mov_b32 s35, 896
    buffer_load_dwordx4 v13, s[40:43], s35 offen lds
    buffer_load_dwordx4 v14, s[40:43], s35 offen offset:1024 lds
    s_add_u32 m0, s101, 73728
    s_mov_b32 s35, 1792
    buffer_load_dwordx4 v13, s[40:43], s35 offen lds
    buffer_load_dwordx4 v14, s[40:43], s35 offen offset:1024 lds
    s_add_u32 m0, s101, 57344
    s_mov_b32 s35, 0
    buffer_load_dwordx4 v13, s[40:43], s35 offen lds
    buffer_load_dwordx4 v14, s[40:43], s35 offen offset:1024 lds
    s_and_b32 s34, s13, 2
    s_lshl_b32 s34, s34, 9
    s_lshl_b32 s35, s14, 5
    s_add_u32 s34, s34, s35
    v_min_u32 v4, 31, v255
    v_add_u32 v4, s34, v4
    v_mul_u32_u24 v16, 896, v4
    v_min_u32 v4, 23, v255
    v_cmp_le_u32 vcc, 12, v4
    s_nop 1
    v_cndmask_b32 v5, 0, 1, vcc
    v_mul_u32_u24 v6, 12, v5
    v_sub_u32 v6, v4, v6
    s_lshl_b32 s34, s14, 1
    v_add_u32 v5, s34, v5
    v_mul_u32_u24 v5, 2688, v5
    v_lshrrev_b32 v4, 2, v6
    v_mul_u32_u24 v4, 896, v4
    v_add_u32 v5, v5, v4
    v_and_b32 v6, 3, v6
    v_lshl_add_u32 v5, v6, 7, v5
    s_and_b32 s34, s13, 1
    s_mul_i32 s34, s34, 512
    v_add_u32 v5, s34, v5
    s_bitcmp1_b32 s96, 0
    s_cselect_b64 vcc, -1, 0
    s_mov_b32 s60, 128
    s_cselect_b32 s60, 172032, s60
    s_cselect_b32 s44, s40, s36
    s_cselect_b32 s45, s41, s37
    s_cselect_b32 s46, s42, s38
    s_mov_b32 s47, 0x20000
    v_cndmask_b32 v16, v16, v5, vcc
    s_lshr_b32 s61, s96, 1
    s_add_u32 s61, s61, 1
    s_mul_i32 s61, s61, s60
    s_lshl_b32 s60, s60, 1
    buffer_load_dword v20, v16, s[44:47], s61 offen
    s_add_u32 s61, s61, s60
    s_add_u32 m0, s97, 81920
    s_mov_b32 s34, 128
    s_mov_b32 s35, 12416
    buffer_load_dwordx4 v10, s[36:39], s34 offen lds
    buffer_load_dwordx4 v11, s[36:39], s34 offen offset:1024 lds
    buffer_load_dwordx4 v10, s[36:39], s35 offen offset:2048 lds
    buffer_load_dwordx4 v11, s[36:39], s35 offen offset:3072 lds
    s_add_u32 m0, s101, 106496
    s_mov_b32 s35, 172928
    buffer_load_dwordx4 v13, s[40:43], s35 offen lds
    buffer_load_dwordx4 v14, s[40:43], s35 offen offset:1024 lds
    s_add_u32 m0, s101, 114688
    s_mov_b32 s35, 173824
    buffer_load_dwordx4 v13, s[40:43], s35 offen lds
    buffer_load_dwordx4 v14, s[40:43], s35 offen offset:1024 lds
    s_add_u32 m0, s101, 98304
    s_mov_b32 s35, 172032
    buffer_load_dwordx4 v13, s[40:43], s35 offen lds
    buffer_load_dwordx4 v14, s[40:43], s35 offen offset:1024 lds
    s_waitcnt vmcnt(11)
    s_barrier
    s_add_u32 m0, s97, 122880
    s_mov_b32 s34, 256
    s_mov_b32 s35, 12544
    buffer_load_dwordx4 v10, s[36:39], s34 offen lds
    buffer_load_dwordx4 v11, s[36:39], s34 offen offset:1024 lds
    buffer_load_dwordx4 v10, s[36:39], s35 offen offset:2048 lds
    buffer_load_dwordx4 v11, s[36:39], s35 offen offset:3072 lds
    s_add_u32 m0, s101, 147456
    s_mov_b32 s35, 344960
    buffer_load_dwordx4 v13, s[40:43], s35 offen lds
    buffer_load_dwordx4 v14, s[40:43], s35 offen offset:1024 lds
    s_add_u32 m0, s101, 155648
    s_mov_b32 s35, 345856
    buffer_load_dwordx4 v13, s[40:43], s35 offen lds
    buffer_load_dwordx4 v14, s[40:43], s35 offen offset:1024 lds
    s_add_u32 m0, s101, 139264
    s_mov_b32 s35, 344064
    buffer_load_dwordx4 v13, s[40:43], s35 offen lds
    buffer_load_dwordx4 v14, s[40:43], s35 offen offset:1024 lds
    buffer_load_dword v20, v16, s[44:47], s61 offen
    s_add_u32 s61, s61, s60
    buffer_load_dword v20, v16, s[44:47], s61 offen
    s_add_u32 s61, s61, s60
    s_waitcnt vmcnt(12)
    s_barrier
    s_add_u32 m0, s97, 0
    s_mov_b32 s34, 384
    s_mov_b32 s35, 12672
    buffer_load_dwordx4 v10, s[36:39], s34 offen lds
    buffer_load_dwordx4 v11, s[36:39], s34 offen offset:1024 lds
    buffer_load_dwordx4 v10, s[36:39], s35 offen offset:2048 lds
    buffer_load_dwordx4 v11, s[36:39], s35 offen offset:3072 lds
    s_add_u32 m0, s101, 24576
    s_mov_b32 s35, 516992
    buffer_load_dwordx4 v13, s[40:43], s35 offen lds
    buffer_load_dwordx4 v14, s[40:43], s35 offen offset:1024 lds
    s_add_u32 m0, s101, 32768
    s_mov_b32 s35, 517888
    buffer_load_dwordx4 v13, s[40:43], s35 offen lds
    buffer_load_dwordx4 v14, s[40:43], s35 offen offset:1024 lds
    s_add_u32 m0, s101, 16384
    s_mov_b32 s35, 516096
    buffer_load_dwordx4 v13, s[40:43], s35 offen lds
    buffer_load_dwordx4 v14, s[40:43], s35 offen offset:1024 lds
    s_lshl_b32 s8, s13, 1
    s_and_b32 s3, s14, 1
    s_add_u32 s8, s8, s3
    s_lshr_b32 s9, s14, 1
    s_lshl_b32 s10, s13, 2
    s_lshr_b32 s3, s14, 3
    s_add_u32 s10, s10, s3
    s_and_b32 s11, s14, 7
    s_mov_b32 s44, s20
    s_mov_b32 s45, s21
    s_mov_b32 s46, 401408
    s_mov_b32 s47, 0x20000
    s_mov_b32 s48, s26
    s_mov_b32 s49, s27
    s_mov_b32 s50, 401408
    s_mov_b32 s51, 0x20000
    s_mov_b32 s52, s32
    s_mov_b32 s53, s33
    s_mov_b32 s54, 18874368
    s_mov_b32 s55, 0x20000
    s_mov_b32 s56, s28
    s_mov_b32 s57, s29
    s_mov_b32 s58, 3670016
    s_mov_b32 s59, 0x20000
    v_and_b32 v5, 6, v1
    v_xor_b32 v5, v2, v5
    v_mul_u32_u24 v4, 896, v1
    s_lshl_b32 s35, s11, 7
    v_add_u32 v4, s35, v4
    v_lshl_add_u32 v15, v5, 4, v4
    s_cmp_eq_u32 s11, 7
    s_cselect_b64 vcc, -1, 0
    v_mov_b32 v7, 1073741824
    v_cndmask_b32 v15, v15, v7, vcc
    v_mov_b32 v1, 0
    s_mul_i32 s3, s14, 98
    s_and_b32 s35, s96, 1
    s_mul_i32 s35, s35, 49
    s_add_u32 s3, s3, s35
    v_min_u32 v4, 48, v255
    v_add_u32 v4, s3, v4
    v_lshlrev_b32 v17, 7, v4
    s_mul_i32 s14, s96, 7168
    s_lshl_b32 s15, s96, 10
    global_load_dword v253, v1, s[30:31] sc1
    s_waitcnt vmcnt(13)
    s_barrier
    s_add_u32 m0, s97, 40960
    s_mov_b32 s34, 512
    s_mov_b32 s35, 12800
    buffer_load_dwordx4 v10, s[36:39], s34 offen lds
    buffer_load_dwordx4 v11, s[36:39], s34 offen offset:1024 lds
    buffer_load_dwordx4 v10, s[36:39], s35 offen offset:2048 lds
    buffer_load_dwordx4 v11, s[36:39], s35 offen offset:3072 lds
    s_add_u32 m0, s101, 65536
    s_mov_b32 s35, 689024
    buffer_load_dwordx4 v13, s[40:43], s35 offen lds
    buffer_load_dwordx4 v14, s[40:43], s35 offen offset:1024 lds
    s_add_u32 m0, s101, 73728
    s_mov_b32 s35, 689920
    buffer_load_dwordx4 v13, s[40:43], s35 offen lds
    buffer_load_dwordx4 v14, s[40:43], s35 offen offset:1024 lds
    s_add_u32 m0, s101, 57344
    s_mov_b32 s35, 688128
    buffer_load_dwordx4 v13, s[40:43], s35 offen lds
    buffer_load_dwordx4 v14, s[40:43], s35 offen offset:1024 lds
    s_waitcnt vmcnt(11)
    s_barrier
    s_add_u32 m0, s97, 81920
    s_mov_b32 s34, 640
    s_mov_b32 s35, 12928
    buffer_load_dwordx4 v10, s[36:39], s34 offen lds
    buffer_load_dwordx4 v11, s[36:39], s34 offen offset:1024 lds
    buffer_load_dwordx4 v10, s[36:39], s35 offen offset:2048 lds
    buffer_load_dwordx4 v11, s[36:39], s35 offen offset:3072 lds
    s_add_u32 m0, s101, 106496
    s_mov_b32 s35, 861056
    buffer_load_dwordx4 v13, s[40:43], s35 offen lds
    buffer_load_dwordx4 v14, s[40:43], s35 offen offset:1024 lds
    s_add_u32 m0, s101, 114688
    s_mov_b32 s35, 861952
    buffer_load_dwordx4 v13, s[40:43], s35 offen lds
    buffer_load_dwordx4 v14, s[40:43], s35 offen offset:1024 lds
    s_add_u32 m0, s101, 98304
    s_mov_b32 s35, 860160
    buffer_load_dwordx4 v13, s[40:43], s35 offen lds
    buffer_load_dwordx4 v14, s[40:43], s35 offen offset:1024 lds
    s_waitcnt vmcnt(10)
    s_barrier
    s_add_u32 m0, s97, 122880
    s_mov_b32 s34, 768
    s_mov_b32 s35, 13056
    buffer_load_dwordx4 v10, s[36:39], s34 offen lds
    buffer_load_dwordx4 v11, s[36:39], s34 offen offset:1024 lds
    buffer_load_dwordx4 v10, s[36:39], s35 offen offset:2048 lds
    buffer_load_dwordx4 v11, s[36:39], s35 offen offset:3072 lds
    s_add_u32 m0, s101, 147456
    s_mov_b32 s35, 1033088
    buffer_load_dwordx4 v13, s[40:43], s35 offen lds
    buffer_load_dwordx4 v14, s[40:43], s35 offen offset:1024 lds
    s_add_u32 m0, s101, 155648
    s_mov_b32 s35, 1033984
    buffer_load_dwordx4 v13, s[40:43], s35 offen lds
    buffer_load_dwordx4 v14, s[40:43], s35 offen offset:1024 lds
    s_add_u32 m0, s101, 139264
    s_mov_b32 s35, 1032192
    buffer_load_dwordx4 v13, s[40:43], s35 offen lds
    buffer_load_dwordx4 v14, s[40:43], s35 offen offset:1024 lds
    s_cmp_lt_u32 s96, 2
    s_cbranch_scc1 L_pwB0
    buffer_load_dword v20, v17, s[44:47], 0 offen
    s_branch L_pwD0
L_pwB0:
    buffer_load_dword v20, v17, s[48:51], 0 offen
L_pwD0:
    s_waitcnt vmcnt(11)
    s_barrier
    s_add_u32 m0, s15, 0
    s_add_u32 s35, s14, 0
    buffer_load_dwordx4 v15, s[48:51], s35 offen lds
    s_add_u32 m0, s15, 4096
    s_add_u32 s35, s14, 28672
    buffer_load_dwordx4 v15, s[48:51], s35 offen lds
    s_add_u32 m0, s15, 8192
    s_add_u32 s35, s14, 57344
    buffer_load_dwordx4 v15, s[48:51], s35 offen lds
    s_add_u32 m0, s15, 12288
    s_add_u32 s35, s14, 86016
    buffer_load_dwordx4 v15, s[48:51], s35 offen lds
    s_add_u32 m0, s15, 16384
    s_add_u32 s35, s14, 114688
    buffer_load_dwordx4 v15, s[48:51], s35 offen lds
    s_add_u32 m0, s15, 20480
    s_add_u32 s35, s14, 143360
    buffer_load_dwordx4 v15, s[48:51], s35 offen lds
    s_add_u32 m0, s15, 24576
    s_add_u32 s35, s14, 172032
    buffer_load_dwordx4 v15, s[48:51], s35 offen lds
    s_add_u32 m0, s15, 28672
    s_add_u32 s35, s14, 200704
    buffer_load_dwordx4 v15, s[48:51], s35 offen lds
    s_add_u32 m0, s15, 32768
    s_add_u32 s35, s14, 229376
    buffer_load_dwordx4 v15, s[48:51], s35 offen lds
    s_add_u32 m0, s15, 36864
    s_add_u32 s35, s14, 258048
    buffer_load_dwordx4 v15, s[48:51], s35 offen lds
    s_waitcnt vmcnt(11)
    s_barrier
    s_barrier
    s_add_u32 m0, s15, 40960
    s_add_u32 s35, s14, 286720
    buffer_load_dwordx4 v15, s[48:51], s35 offen lds
    s_add_u32 m0, s15, 45056
    s_add_u32 s35, s14, 315392
    buffer_load_dwordx4 v15, s[48:51], s35 offen lds
    s_add_u32 m0, s15, 49152
    s_add_u32 s35, s14, 344064
    buffer_load_dwordx4 v15, s[48:51], s35 offen lds
    s_add_u32 m0, s15, 53248
    s_add_u32 s35, s14, 372736
    buffer_load_dwordx4 v15, s[48:51], s35 offen lds
    s_add_u32 m0, s15, 57344
    s_add_u32 s35, s14, 0
    buffer_load_dwordx4 v15, s[44:47], s35 offen lds
    s_add_u32 m0, s15, 61440
    s_add_u32 s35, s14, 28672
    buffer_load_dwordx4 v15, s[44:47], s35 offen lds
    s_add_u32 m0, s15, 65536
    s_add_u32 s35, s14, 57344
    buffer_load_dwordx4 v15, s[44:47], s35 offen lds
    s_add_u32 m0, s15, 69632
    s_add_u32 s35, s14, 86016
    buffer_load_dwordx4 v15, s[44:47], s35 offen lds
    s_add_u32 m0, s15, 73728
    s_add_u32 s35, s14, 114688
    buffer_load_dwordx4 v15, s[44:47], s35 offen lds
    s_add_u32 m0, s15, 77824
    s_add_u32 s35, s14, 143360
    buffer_load_dwordx4 v15, s[44:47], s35 offen lds
    s_branch L_ld2
L_ld_idle:
    s_and_b32 s34, s13, 2
    s_lshl_b32 s34, s34, 9
    s_lshl_b32 s35, s14, 5
    s_add_u32 s34, s34, s35
    v_min_u32 v4, 31, v255
    v_add_u32 v4, s34, v4
    v_mul_u32_u24 v16, 896, v4
    v_min_u32 v4, 23, v255
    v_cmp_le_u32 vcc, 12, v4
    s_nop 1
    v_cndmask_b32 v5, 0, 1, vcc
    v_mul_u32_u24 v6, 12, v5
    v_sub_u32 v6, v4, v6
    s_lshl_b32 s34, s14, 1
    v_add_u32 v5, s34, v5
    v_mul_u32_u24 v5, 2688, v5
    v_lshrrev_b32 v4, 2, v6
    v_mul_u32_u24 v4, 896, v4
    v_add_u32 v5, v5, v4
    v_and_b32 v6, 3, v6
    v_lshl_add_u32 v5, v6, 7, v5
    s_and_b32 s34, s13, 1
    s_mul_i32 s34, s34, 512
    v_add_u32 v5, s34, v5
    s_bitcmp1_b32 s96, 0
    s_cselect_b64 vcc, -1, 0
    s_mov_b32 s60, 128
    s_cselect_b32 s60, 172032, s60
    s_cselect_b32 s44, s40, s36
    s_cselect_b32 s45, s41, s37
    s_cselect_b32 s46, s42, s38
    s_mov_b32 s47, 0x20000
    v_cndmask_b32 v16, v16, v5, vcc
    s_lshr_b32 s61, s96, 1
    s_add_u32 s61, s61, 1
    s_mul_i32 s61, s61, s60
    s_lshl_b32 s60, s60, 1
    buffer_load_dword v20, v16, s[44:47], s61 offen
    s_add_u32 s61, s61, s60
    buffer_load_dword v20, v16, s[44:47], s61 offen
    s_add_u32 s61, s61, s60
    buffer_load_dword v20, v16, s[44:47], s61 offen
    s_add_u32 s61, s61, s60
    s_lshl_b32 s8, s13, 1
    s_and_b32 s3, s14, 1
    s_add_u32 s8, s8, s3
    s_lshr_b32 s9, s14, 1
    s_lshl_b32 s10, s13, 2
    s_lshr_b32 s3, s14, 3
    s_add_u32 s10, s10, s3
    s_and_b32 s11, s14, 7
    s_mov_b32 s44, s20
    s_mov_b32 s45, s21
    s_mov_b32 s46, 401408
    s_mov_b32 s47, 0x20000
    s_mov_b32 s48, s26
    s_mov_b32 s49, s27
    s_mov_b32 s50, 401408
    s_mov_b32 s51, 0x20000
    s_mov_b32 s52, s32
    s_mov_b32 s53, s33
    s_mov_b32 s54, 18874368
    s_mov_b32 s55, 0x20000
    s_mov_b32 s56, s28
    s_mov_b32 s57, s29
    s_mov_b32 s58, 3670016
    s_mov_b32 s59, 0x20000
    v_and_b32 v5, 6, v1
    v_xor_b32 v5, v2, v5
    v_mul_u32_u24 v4, 896, v1
    s_lshl_b32 s35, s11, 7
    v_add_u32 v4, s35, v4
    v_lshl_add_u32 v15, v5, 4, v4
    s_cmp_eq_u32 s11, 7
    s_cselect_b64 vcc, -1, 0
    v_mov_b32 v7, 1073741824
    v_cndmask_b32 v15, v15, v7, vcc
    v_mov_b32 v1, 0
    s_mul_i32 s3, s14, 98
    s_and_b32 s35, s96, 1
    s_mul_i32 s35, s35, 49
    s_add_u32 s3, s3, s35
    v_min_u32 v4, 48, v255
    v_add_u32 v4, s3, v4
    v_lshlrev_b32 v17, 7, v4
    s_mul_i32 s14, s96, 7168
    s_lshl_b32 s15, s96, 10
    global_load_dword v253, v1, s[30:31] sc1
    s_cmp_lt_u32 s96, 2
    s_cbranch_scc1 L_pwB1
    buffer_load_dword v20, v17, s[44:47], 0 offen
    s_branch L_pwD1
L_pwB1:
    buffer_load_dword v20, v17, s[48:51], 0 offen
L_pwD1:
    s_add_u32 m0, s15, 0
    s_add_u32 s35, s14, 0
    buffer_load_dwordx4 v15, s[48:51], s35 offen lds
    s_add_u32 m0, s15, 4096
    s_add_u32 s35, s14, 28672
    buffer_load_dwordx4 v15, s[48:51], s35 offen lds
    s_add_u32 m0, s15, 8192
    s_add_u32 s35, s14, 57344
    buffer_load_dwordx4 v15, s[48:51], s35 offen lds
    s_add_u32 m0, s15, 12288
    s_add_u32 s35, s14, 86016
    buffer_load_dwordx4 v15, s[48:51], s35 offen lds
    s_add_u32 m0, s15, 16384
    s_add_u32 s35, s14, 114688
    buffer_load_dwordx4 v15, s[48:51], s35 offen lds
    s_add_u32 m0, s15, 20480
    s_add_u32 s35, s14, 143360
    buffer_load_dwordx4 v15, s[48:51], s35 offen lds
    s_add_u32 m0, s15, 24576
    s_add_u32 s35, s14, 172032
    buffer_load_dwordx4 v15, s[48:51], s35 offen lds
    s_add_u32 m0, s15, 28672
    s_add_u32 s35, s14, 200704
    buffer_load_dwordx4 v15, s[48:51], s35 offen lds
    s_add_u32 m0, s15, 32768
    s_add_u32 s35, s14, 229376
    buffer_load_dwordx4 v15, s[48:51], s35 offen lds
    s_add_u32 m0, s15, 36864
    s_add_u32 s35, s14, 258048
    buffer_load_dwordx4 v15, s[48:51], s35 offen lds
    s_add_u32 m0, s15, 40960
    s_add_u32 s35, s14, 286720
    buffer_load_dwordx4 v15, s[48:51], s35 offen lds
    s_add_u32 m0, s15, 45056
    s_add_u32 s35, s14, 315392
    buffer_load_dwordx4 v15, s[48:51], s35 offen lds
    s_add_u32 m0, s15, 49152
    s_add_u32 s35, s14, 344064
    buffer_load_dwordx4 v15, s[48:51], s35 offen lds
    s_add_u32 m0, s15, 53248
    s_add_u32 s35, s14, 372736
    buffer_load_dwordx4 v15, s[48:51], s35 offen lds
    s_add_u32 m0, s15, 57344
    s_add_u32 s35, s14, 0
    buffer_load_dwordx4 v15, s[44:47], s35 offen lds
    s_add_u32 m0, s15, 61440
    s_add_u32 s35, s14, 28672
    buffer_load_dwordx4 v15, s[44:47], s35 offen lds
    s_add_u32 m0, s15, 65536
    s_add_u32 s35, s14, 57344
    buffer_load_dwordx4 v15, s[44:47], s35 offen lds
    s_add_u32 m0, s15, 69632
    s_add_u32 s35, s14, 86016
    buffer_load_dwordx4 v15, s[44:47], s35 offen lds
    s_add_u32 m0, s15, 73728
    s_add_u32 s35, s14, 114688
    buffer_load_dwordx4 v15, s[44:47], s35 offen lds
    s_add_u32 m0, s15, 77824
    s_add_u32 s35, s14, 143360
    buffer_load_dwordx4 v15, s[44:47], s35 offen lds
L_ld2:
    s_add_u32 m0, s15, 81920
    s_add_u32 s35, s14, 172032
    buffer_load_dwordx4 v15, s[44:47], s35 offen lds
    s_add_u32 m0, s15, 86016
    s_add_u32 s35, s14, 200704
    buffer_load_dwordx4 v15, s[44:47], s35 offen lds
    s_add_u32 m0, s15, 90112
    s_add_u32 s35, s14, 229376
    buffer_load_dwordx4 v15, s[44:47], s35 offen lds
    s_add_u32 m0, s15, 94208
    s_add_u32 s35, s14, 258048
    buffer_load_dwordx4 v15, s[44:47], s35 offen lds
    s_add_u32 m0, s15, 98304
    s_add_u32 s35, s14, 286720
    buffer_load_dwordx4 v15, s[44:47], s35 offen lds
    s_add_u32 m0, s15, 102400
    s_add_u32 s35, s14, 315392
    buffer_load_dwordx4 v15, s[44:47], s35 offen lds
    s_add_u32 m0, s15, 106496
    s_add_u32 s35, s14, 344064
    buffer_load_dwordx4 v15, s[44:47], s35 offen lds
    s_add_u32 m0, s15, 110592
    s_add_u32 s35, s14, 372736
    buffer_load_dwordx4 v15, s[44:47], s35 offen lds
    s_and_b32 s60, s4, 1
    s_lshr_b32 s61, s4, 1
    v_and_b32 v240, 15, v255
    v_lshrrev_b32 v241, 4, v255
    v_cmp_gt_u32 vcc, 48, v255
    s_nop 1
    v_cndmask_b32 v250, 0, -1, vcc
    v_lshrrev_b32 v220, 2, v240
    v_lshl_add_u32 v221, v241, 2, v220
    v_lshlrev_b32 v221, 7, v221
    s_mul_i32 s3, s61, 14336
    v_add_u32 v221, s3, v221
    v_and_b32 v222, 2, v220
    v_and_b32 v223, 1, v241
    v_lshl_or_b32 v222, v223, 2, v222
    v_lshlrev_b32 v222, 4, v222
    v_and_b32 v223, 3, v255
    v_lshlrev_b32 v224, 3, v223
    v_xor_b32 v222, v222, v224
    v_add_u32 v221, v221, v222
    v_and_b32 v222, 2048, v250
    s_add_u32 s3, s61, 0
    s_and_b32 s3, s3, 3
    s_lshl_b32 s3, s3, 5
    v_xor_b32 v242, s3, v221
    v_add_u32 v246, v242, v222
    s_add_u32 s3, s61, 1
    s_and_b32 s3, s3, 3
    s_lshl_b32 s3, s3, 5
    v_xor_b32 v243, s3, v221
    v_add_u32 v247, v243, v222
    s_add_u32 s3, s61, 2
    s_and_b32 s3, s3, 3
    s_lshl_b32 s3, s3, 5
    v_xor_b32 v244, s3, v221
    v_add_u32 v248, v244, v222
    s_add_u32 s3, s61, 3
    s_and_b32 s3, s3, 3
    s_lshl_b32 s3, s3, 5
    v_xor_b32 v245, s3, v221
    v_add_u32 v249, v245, v222
    v_mov_b32 v224, 1073741824
    v_lshlrev_b32 v232, 9, v241
    v_lshl_add_u32 v232, v240, 4, v232
    v_lshlrev_b32 v233, 6, v240
    v_lshl_add_u32 v233, v241, 4, v233
    v_lshlrev_b32 v234, 8, v220
    v_lshl_add_u32 v234, v241, 6, v234
    v_lshl_add_u32 v234, v223, 4, v234
    v_add_u32 v235, 1024, v234
    v_cmp_gt_u32 vcc, 12, v240
    s_nop 1
    v_cndmask_b32 v235, v224, v235, vcc
    v_cmp_eq_u32 vcc, 12, v240
    v_mov_b32 v224, 0x3f803f80
    s_nop 0
    v_cndmask_b32 v236, 0, v224, vcc
    v_mov_b32 v252, 1049335798
    v_mov_b32 v237, 4048155338
    s_and_b32 s3, s4, 6
    s_lshl_b32 s3, s3, 10
    s_add_u32 s3, s3, 114688
    v_add_u32 v239, s3, v254
    s_mul_i32 s3, s8, 7
    s_lshr_b32 s100, s3, 1
    s_lshl_b32 s100, s100, 9
    s_lshl_b32 s98, s3, 8
    v_cmp_lt_u32 vcc, 15, v255
    s_nop 1
    v_cndmask_b32 v220, 0, -1, vcc
    s_bitcmp1_b32 s8, 0
    s_cselect_b64 vcc, -1, 0
    v_cndmask_b32 v228, -1, v220, vcc
    v_cndmask_b32 v229, v250, -1, vcc
    s_mul_i32 s3, s4, 3
    s_lshl_b32 s62, s9, 3
    s_sub_u32 s62, s62, 16
    s_add_u32 s62, s62, s3
    s_lshl_b32 s3, s3, 10
    s_add_u32 s3, s3, 114688
    v_add_u32 v238, s3, v254
    v_subrev_u32 v220, 1024, v235
    s_bitcmp1_b32 s4, 0
    s_cselect_b64 vcc, -1, 0
    v_cndmask_b32 v251, v234, v220, vcc
    v_cndmask_b32 v226, v220, v234, vcc
    v_cndmask_b32 v230, 0, v236, vcc
    v_cndmask_b32 v231, v236, 0, vcc
    s_ashr_i32 s34, s62, 1
    s_mul_i32 s34, s34, 28672
    s_and_b32 s35, s62, 1
    s_lshl_b32 s3, s35, 10
    s_add_u32 s3, s3, s34
    s_add_u32 s3, s3, s98
    s_add_u32 s3, s3, 4194304
    s_lshl_b32 s35, s35, 8
    s_add_u32 s35, s35, s34
    s_add_u32 s35, s35, s100
    s_add_u32 s35, s35, 2097152
    s_cmp_lt_i32 s62, 0
    s_cselect_b32 s22, 1073741824, s3
    s_cselect_b32 s16, 1073741824, s35
    s_add_u32 s62, s62, 1
    s_ashr_i32 s34, s62, 1
    s_mul_i32 s34, s34, 28672
    s_and_b32 s35, s62, 1
    s_lshl_b32 s3, s35, 10
    s_add_u32 s3, s3, s34
    s_add_u32 s3, s3, s98
    s_add_u32 s3, s3, 4194304
    s_lshl_b32 s35, s35, 8
    s_add_u32 s35, s35, s34
    s_add_u32 s35, s35, s100
    s_add_u32 s35, s35, 2097152
    s_cmp_lt_i32 s62, 0
    s_cselect_b32 s23, 1073741824, s3
    s_cselect_b32 s17, 1073741824, s35
    s_add_u32 s62, s62, 1
    s_ashr_i32 s34, s62, 1
    s_mul_i32 s34, s34, 28672
    s_and_b32 s35, s62, 1
    s_lshl_b32 s3, s35, 10
    s_add_u32 s3, s3, s34
    s_add_u32 s3, s3, s98
    s_add_u32 s3, s3, 4194304
    s_lshl_b32 s35, s35, 8
    s_add_u32 s35, s35, s34
    s_add_u32 s35, s35, s100
    s_add_u32 s35, s35, 2097152
    s_cmp_lt_i32 s62, 0
    s_cselect_b32 s24, 1073741824, s3
    s_cselect_b32 s18, 1073741824, s35
    s_add_u32 s62, s62, 1
    s_lshl_b32 s3, s9, 3
    s_add_u32 s3, s3, s4
    s_lshr_b32 s34, s3, 1
    s_mul_i32 s34, s34, 28672
    s_and_b32 s35, s3, 1
    s_lshl_b32 s35, s35, 8
    s_add_u32 s35, s35, s34
    s_add_u32 s32, s35, s100
    s_lshl_b32 s3, s3, 4
    s_add_u32 s3, s3, s8
    s_lshl_b32 s3, s3, 10
    s_add_u32 s33, s3, 12582912
    s_mul_i32 s3, s8, 7
    s_lshr_b32 s34, s3, 3
    s_add_u32 s3, s3, 6
    s_lshr_b32 s35, s3, 3
    s_sub_u32 s35, s35, s34
    v_and_b32 v220, 1, v255
    v_mul_u32_u24 v220, s35, v220
    v_add_u32 v220, s34, v220
    v_min_u32 v221, 11, v255
    v_lshrrev_b32 v221, 1, v221
    s_lshl_b32 s3, s9, 1
    s_sub_u32 s3, s3, 4
    v_add_u32 v221, s3, v221
    v_max_i32 v221, 0, v221
    v_lshl_add_u32 v221, v221, 4, v220
    v_lshlrev_b32 v225, 7, v221
    s_lshl_b32 s3, s10, 2
    s_lshl_b32 s35, s60, 1
    s_add_u32 s3, s3, s35
    s_lshl_b32 s3, s3, 4
    s_lshl_b32 s35, s61, 2
    s_add_u32 s3, s3, s35
    s_lshl_b32 s3, s3, 10
    s_add_u32 s96, s3, 14680064
    s_add_u32 s97, s96, 16384
    s_add_u32 s28, s3, 12582912
    s_add_u32 s29, s28, 16384
    s_mov_b32 s15, 16777216
    s_waitcnt vmcnt(0)
    s_mov_b32 s35, 40000
L_tagl:
    v_readfirstlane_b32 s12, v253
    s_nop 3
    s_cmp_lg_u32 s12, 0
    s_cbranch_scc1 L_tagokl
    v_mov_b32 v227, 0
    global_load_dword v253, v227, s[30:31] sc1
    s_sub_u32 s35, s35, 1
    s_waitcnt vmcnt(0)
    s_cmp_lg_u32 s35, 0
    s_cbranch_scc1 L_tagl
L_tagokl:
    s_branch L_phase2
L_compute:
    s_waitcnt lgkmcnt(0)
    v_mov_b32 v1, 0
    s_lshl_b32 s8, s13, 1
    s_and_b32 s3, s14, 1
    s_add_u32 s8, s8, s3
    s_lshr_b32 s9, s14, 1
    s_lshl_b32 s10, s13, 2
    s_lshr_b32 s3, s14, 3
    s_add_u32 s10, s10, s3
    s_and_b32 s11, s14, 7
    s_mov_b32 s44, s20
    s_mov_b32 s45, s21
    s_mov_b32 s46, 401408
    s_mov_b32 s47, 0x20000
    s_mov_b32 s48, s26
    s_mov_b32 s49, s27
    s_mov_b32 s50, 401408
    s_mov_b32 s51, 0x20000
    s_mov_b32 s52, s32
    s_mov_b32 s53, s33
    s_mov_b32 s54, 18874368
    s_mov_b32 s55, 0x20000
    s_mov_b32 s56, s28
    s_mov_b32 s57, s29
    s_mov_b32 s58, 3670016
    s_mov_b32 s59, 0x20000
    s_and_b32 s96, s4, 1
    s_lshr_b32 s97, s4, 1
    s_cmp_eq_u32 s6, 7
    s_cbranch_scc1 L_cmp_idle
    v_and_b32 v2, 31, v255
    v_lshrrev_b32 v3, 5, v255
    v_bfe_u32 v4, v255, 2, 2
    s_lshl_b32 s3, s6, 1
    s_add_u32 s3, s3, s96
    s_lshl_b32 s34, s3, 11
    v_add_u32 v205, s34, v254
    v_bfe_u32 v6, v255, 4, 1
    v_lshlrev_b32 v6, 2, v6
    v_and_b32 v7, 1, v4
    v_lshl_add_u32 v6, v7, 1, v6
    v_lshrrev_b32 v7, 1, v4
    v_add_u32 v6, v6, v7
    v_lshl_add_u32 v7, v6, 8, s34
    v_lshl_add_u32 v7, v3, 6, v7
    v_and_b32 v8, 3, v255
    v_lshl_add_u32 v206, v8, 4, v7
    s_lshl_b32 s34, s7, 1
    s_add_u32 s34, s34, s97
    s_mul_i32 s36, s34, 57344
    s_add_u32 s39, s36, 28672
    s_add_u32 s37, s36, 2097152
    s_add_u32 s40, s39, 2097152
    s_add_u32 s38, s36, 4194304
    s_add_u32 s15, s39, 4194304
    s_lshl_b32 s34, s34, 4
    s_add_u32 s34, s34, s3
    s_lshl_b32 s34, s34, 7
    s_add_u32 s41, s34, 16777216
    global_load_dword v253, v1, s[30:31] sc1
    s_lshl_b32 s3, s97, 6
    v_add_u32 v5, s3, v2
    v_lshlrev_b32 v5, 7, v5
    v_bfe_u32 v6, v2, 1, 3
    v_xor_b32 v6, v6, v3
    v_lshl_add_u32 v200, v6, 4, v5
    v_add_u32 v200, 40960, v200
    v_xor_b32 v201, 32, v200
    v_xor_b32 v202, 64, v200
    v_xor_b32 v203, 96, v200
    v_lshl_add_u32 v6, v3, 3, v4
    v_lshlrev_b32 v6, 7, v6
    v_add_u32 v6, 57344, v6
    v_bfe_u32 v7, v255, 4, 1
    v_lshlrev_b32 v7, 5, v7
    v_and_b32 v8, 1, v255
    v_lshl_or_b32 v7, v8, 4, v7
    v_bfe_u32 v8, v255, 1, 1
    v_lshl_or_b32 v7, v8, 3, v7
    s_lshl_b32 s3, s96, 6
    v_or_b32 v7, s3, v7
    v_and_b32 v8, 2, v4
    v_lshlrev_b32 v8, 5, v8
    v_xor_b32 v7, v7, v8
    v_add_u32 v204, v6, v7
    s_barrier
    ds_read_b128 v[96:99], v200 offset:0
    ds_read_b128 v[100:103], v200 offset:4096
    ds_read_b64_tr_b16 v[108:109], v204 offset:8192
    ds_read_b64_tr_b16 v[110:111], v204 offset:8704
    ds_read_b64_tr_b16 v[112:113], v204 offset:16384
    ds_read_b64_tr_b16 v[114:115], v204 offset:16896
    ds_read_b64_tr_b16 v[104:105], v204 offset:0
    ds_read_b64_tr_b16 v[106:107], v204 offset:512
    s_mov_b32 s42, 0
    s_waitcnt lgkmcnt(0)
    v_mfma_f32_32x32x16_bf16 v[32:47], v[108:111], v[96:99], 0
    ds_read_b128 v[116:119], v201 offset:0
    ds_read_b128 v[120:123], v201 offset:4096
    ds_read_b64_tr_b16 v[128:129], v204 offset:10240
    v_mfma_f32_32x32x16_bf16 v[48:63], v[108:111], v[100:103], 0
    ds_read_b64_tr_b16 v[130:131], v204 offset:10752
    ds_read_b64_tr_b16 v[132:133], v204 offset:18432
    ds_read_b64_tr_b16 v[134:135], v204 offset:18944
    v_mfma_f32_32x32x16_bf16 v[64:79], v[96:99], v[112:115], 0
    ds_read_b64_tr_b16 v[124:125], v204 offset:2048
    ds_read_b64_tr_b16 v[126:127], v204 offset:2560
    v_mfma_f32_32x32x16_bf16 v[80:95], v[100:103], v[112:115], 0
    s_and_b32 s3, s42, 3
    s_cmp_eq_u32 s3, 2
    s_mov_b32 s43, 40960
    s_cselect_b32 s43, 4294844416, s43
    v_mfma_f32_32x32x16_bf16 v[0:15], v[104:107], v[96:99], 0
    v_add_u32 v200, s43, v200
    v_add_u32 v201, s43, v201
    v_mfma_f32_32x32x16_bf16 v[16:31], v[104:107], v[100:103], 0
    s_branch L_gemm1
L_gemm:
    s_waitcnt lgkmcnt(0)
    v_mfma_f32_32x32x16_bf16 v[32:47], v[108:111], v[96:99], v[32:47]
    ds_read_b128 v[116:119], v201 offset:0
    ds_read_b128 v[120:123], v201 offset:4096
    ds_read_b64_tr_b16 v[128:129], v204 offset:10240
    v_mfma_f32_32x32x16_bf16 v[48:63], v[108:111], v[100:103], v[48:63]
    ds_read_b64_tr_b16 v[130:131], v204 offset:10752
    ds_read_b64_tr_b16 v[132:133], v204 offset:18432
    ds_read_b64_tr_b16 v[134:135], v204 offset:18944
    v_mfma_f32_32x32x16_bf16 v[64:79], v[96:99], v[112:115], v[64:79]
    ds_read_b64_tr_b16 v[124:125], v204 offset:2048
    ds_read_b64_tr_b16 v[126:127], v204 offset:2560
    v_mfma_f32_32x32x16_bf16 v[80:95], v[100:103], v[112:115], v[80:95]
    s_and_b32 s3, s42, 3
    s_cmp_eq_u32 s3, 2
    s_mov_b32 s43, 40960
    s_cselect_b32 s43, 4294844416, s43
    v_mfma_f32_32x32x16_bf16 v[0:15], v[104:107], v[96:99], v[0:15]
    v_add_u32 v200, s43, v200
    v_add_u32 v201, s43, v201
    v_mfma_f32_32x32x16_bf16 v[16:31], v[104:107], v[100:103], v[16:31]
L_gemm1:
    s_waitcnt lgkmcnt(0)
    v_mfma_f32_32x32x16_bf16 v[32:47], v[128:131], v[116:119], v[32:47]
    ds_read_b128 v[96:99], v202 offset:0
    ds_read_b128 v[100:103], v202 offset:4096
    ds_read_b64_tr_b16 v[108:109], v204 offset:12288
    v_mfma_f32_32x32x16_bf16 v[48:63], v[128:131], v[120:123], v[48:63]
    ds_read_b64_tr_b16 v[110:111], v204 offset:12800
    ds_read_b64_tr_b16 v[112:113], v204 offset:20480
    ds_read_b64_tr_b16 v[114:115], v204 offset:20992
    v_mfma_f32_32x32x16_bf16 v[64:79], v[116:119], v[132:135], v[64:79]
    ds_read_b64_tr_b16 v[104:105], v204 offset:4096
    ds_read_b64_tr_b16 v[106:107], v204 offset:4608
    v_mfma_f32_32x32x16_bf16 v[80:95], v[120:123], v[132:135], v[80:95]
    v_add_u32 v202, s43, v202
    v_mfma_f32_32x32x16_bf16 v[0:15], v[124:127], v[116:119], v[0:15]
    v_mfma_f32_32x32x16_bf16 v[16:31], v[124:127], v[120:123], v[16:31]
    s_waitcnt lgkmcnt(0)
    v_mfma_f32_32x32x16_bf16 v[32:47], v[108:111], v[96:99], v[32:47]
    ds_read_b128 v[116:119], v203 offset:0
    ds_read_b128 v[120:123], v203 offset:4096
    ds_read_b64_tr_b16 v[128:129], v204 offset:14336
    v_mfma_f32_32x32x16_bf16 v[48:63], v[108:111], v[100:103], v[48:63]
    ds_read_b64_tr_b16 v[130:131], v204 offset:14848
    ds_read_b64_tr_b16 v[132:133], v204 offset:22528
    ds_read_b64_tr_b16 v[134:135], v204 offset:23040
    v_mfma_f32_32x32x16_bf16 v[64:79], v[96:99], v[112:115], v[64:79]
    ds_read_b64_tr_b16 v[124:125], v204 offset:6144
    ds_read_b64_tr_b16 v[126:127], v204 offset:6656
    v_mfma_f32_32x32x16_bf16 v[80:95], v[100:103], v[112:115], v[80:95]
    v_add_u32 v203, s43, v203
    v_add_u32 v204, s43, v204
    s_add_u32 s42, s42, 1
    s_cmp_lt_u32 s42, 6
    v_mfma_f32_32x32x16_bf16 v[0:15], v[104:107], v[96:99], v[0:15]
    v_mfma_f32_32x32x16_bf16 v[16:31], v[104:107], v[100:103], v[16:31]
    s_waitcnt lgkmcnt(0)
    s_barrier
    v_mfma_f32_32x32x16_bf16 v[32:47], v[128:131], v[116:119], v[32:47]
    ds_read_b128 v[96:99], v200 offset:0
    ds_read_b128 v[100:103], v200 offset:4096
    ds_read_b64_tr_b16 v[108:109], v204 offset:8192
    v_mfma_f32_32x32x16_bf16 v[48:63], v[128:131], v[120:123], v[48:63]
    ds_read_b64_tr_b16 v[110:111], v204 offset:8704
    ds_read_b64_tr_b16 v[112:113], v204 offset:16384
    ds_read_b64_tr_b16 v[114:115], v204 offset:16896
    v_mfma_f32_32x32x16_bf16 v[64:79], v[116:119], v[132:135], v[64:79]
    ds_read_b64_tr_b16 v[104:105], v204 offset:0
    ds_read_b64_tr_b16 v[106:107], v204 offset:512
    v_mfma_f32_32x32x16_bf16 v[80:95], v[120:123], v[132:135], v[80:95]
    v_mfma_f32_32x32x16_bf16 v[0:15], v[124:127], v[116:119], v[0:15]
    v_mfma_f32_32x32x16_bf16 v[16:31], v[124:127], v[120:123], v[16:31]
    s_cbranch_scc1 L_gemm
    s_waitcnt vmcnt(0) lgkmcnt(0)
    v_mfma_f32_32x32x16_bf16 v[32:47], v[108:111], v[96:99], v[32:47]
    ds_read_b128 v[116:119], v201 offset:0
    ds_read_b128 v[120:123], v201 offset:4096
    ds_read_b64_tr_b16 v[128:129], v204 offset:10240
    v_mfma_f32_32x32x16_bf16 v[48:63], v[108:111], v[100:103], v[48:63]
    ds_read_b64_tr_b16 v[130:131], v204 offset:10752
    ds_read_b128 v[136:139], v202 offset:0
    ds_read_b128 v[140:143], v202 offset:4096
    v_mfma_f32_32x32x16_bf16 v[0:15], v[104:107], v[96:99], v[0:15]
    ds_read_b64_tr_b16 v[148:149], v204 offset:12288
    ds_read_b64_tr_b16 v[150:151], v204 offset:12800
    ds_read_b128 v[156:159], v203 offset:0
    v_mfma_f32_32x32x16_bf16 v[16:31], v[104:107], v[100:103], v[16:31]
    ds_read_b128 v[160:163], v203 offset:4096
    ds_read_b64_tr_b16 v[168:169], v204 offset:14336
    ds_read_b64_tr_b16 v[170:171], v204 offset:14848
    v_mfma_f32_32x32x16_bf16 v[64:79], v[96:99], v[112:115], v[64:79]
    ds_read_b64_tr_b16 v[124:125], v204 offset:2048
    ds_read_b64_tr_b16 v[126:127], v204 offset:2560
    ds_read_b64_tr_b16 v[144:145], v204 offset:4096
    v_mfma_f32_32x32x16_bf16 v[80:95], v[100:103], v[112:115], v[80:95]
    ds_read_b64_tr_b16 v[146:147], v204 offset:4608
    ds_read_b64_tr_b16 v[164:165], v204 offset:6144
    ds_read_b64_tr_b16 v[166:167], v204 offset:6656
    s_waitcnt lgkmcnt(14)
    v_mfma_f32_32x32x16_bf16 v[32:47], v[128:131], v[116:119], v[32:47]
    ds_read_b64_tr_b16 v[132:133], v204 offset:18432
    v_mfma_f32_32x32x16_bf16 v[48:63], v[128:131], v[120:123], v[48:63]
    ds_read_b64_tr_b16 v[134:135], v204 offset:18944
    s_waitcnt lgkmcnt(12)
    v_mfma_f32_32x32x16_bf16 v[32:47], v[148:151], v[136:139], v[32:47]
    ds_read_b64_tr_b16 v[152:153], v204 offset:20480
    v_mfma_f32_32x32x16_bf16 v[48:63], v[148:151], v[140:143], v[48:63]
    ds_read_b64_tr_b16 v[154:155], v204 offset:20992
    s_waitcnt lgkmcnt(10)
    v_mfma_f32_32x32x16_bf16 v[32:47], v[168:171], v[156:159], v[32:47]
    ds_read_b64_tr_b16 v[172:173], v204 offset:22528
    v_mfma_f32_32x32x16_bf16 v[48:63], v[168:171], v[160:163], v[48:63]
    ds_read_b64_tr_b16 v[174:175], v204 offset:23040
    s_waitcnt lgkmcnt(10)
    v_mfma_f32_32x32x16_bf16 v[0:15], v[124:127], v[116:119], v[0:15]
    v_mfma_f32_32x32x16_bf16 v[16:31], v[124:127], v[120:123], v[16:31]
    s_nop 5
    v_cvt_pk_bf16_f32 v32, v32, v33
    v_cvt_pk_bf16_f32 v33, v34, v35
    v_cvt_pk_bf16_f32 v34, v36, v37
    v_cvt_pk_bf16_f32 v35, v38, v39
    s_waitcnt lgkmcnt(8)
    v_mfma_f32_32x32x16_bf16 v[0:15], v[144:147], v[136:139], v[0:15]
    buffer_store_dwordx4 v[32:35], v205, s[52:55], s37 offen offset:0 sc1
    v_cvt_pk_bf16_f32 v40, v40, v41
    v_cvt_pk_bf16_f32 v41, v42, v43
    v_cvt_pk_bf16_f32 v42, v44, v45
    v_mfma_f32_32x32x16_bf16 v[16:31], v[144:147], v[140:143], v[16:31]
    v_cvt_pk_bf16_f32 v43, v46, v47
    buffer_store_dwordx4 v[40:43], v205, s[52:55], s37 offen offset:1024 sc1
    v_cvt_pk_bf16_f32 v48, v48, v49
    v_cvt_pk_bf16_f32 v49, v50, v51
    s_waitcnt lgkmcnt(6)
    v_mfma_f32_32x32x16_bf16 v[0:15], v[164:167], v[156:159], v[0:15]
    v_cvt_pk_bf16_f32 v50, v52, v53
    v_cvt_pk_bf16_f32 v51, v54, v55
    buffer_store_dwordx4 v[48:51], v205, s[52:55], s40 offen offset:0 sc1
    v_cvt_pk_bf16_f32 v56, v56, v57
    v_mfma_f32_32x32x16_bf16 v[16:31], v[164:167], v[160:163], v[16:31]
    v_cvt_pk_bf16_f32 v57, v58, v59
    v_cvt_pk_bf16_f32 v58, v60, v61
    v_cvt_pk_bf16_f32 v59, v62, v63
    buffer_store_dwordx4 v[56:59], v205, s[52:55], s40 offen offset:1024 sc1
    s_waitcnt lgkmcnt(4)
    v_mfma_f32_32x32x16_bf16 v[64:79], v[116:119], v[132:135], v[64:79]
    v_mfma_f32_32x32x16_bf16 v[80:95], v[120:123], v[132:135], v[80:95]
    v_cvt_pk_bf16_f32 v0, v0, v1
    v_cvt_pk_bf16_f32 v1, v2, v3
    v_cvt_pk_bf16_f32 v2, v4, v5
    v_cvt_pk_bf16_f32 v3, v6, v7
    s_waitcnt lgkmcnt(2)
    v_mfma_f32_32x32x16_bf16 v[64:79], v[136:139], v[152:155], v[64:79]
    buffer_store_dwordx4 v[0:3], v205, s[52:55], s36 offen offset:0 sc1
    v_cvt_pk_bf16_f32 v8, v8, v9
    v_cvt_pk_bf16_f32 v9, v10, v11
    v_cvt_pk_bf16_f32 v10, v12, v13
    v_mfma_f32_32x32x16_bf16 v[80:95], v[140:143], v[152:155], v[80:95]
    v_cvt_pk_bf16_f32 v11, v14, v15
    buffer_store_dwordx4 v[8:11], v205, s[52:55], s36 offen offset:1024 sc1
    v_cvt_pk_bf16_f32 v16, v16, v17
    v_cvt_pk_bf16_f32 v17, v18, v19
    s_waitcnt lgkmcnt(0)
    v_mfma_f32_32x32x16_bf16 v[64:79], v[156:159], v[172:175], v[64:79]
    v_cvt_pk_bf16_f32 v18, v20, v21
    v_cvt_pk_bf16_f32 v19, v22, v23
    buffer_store_dwordx4 v[16:19], v205, s[52:55], s39 offen offset:0 sc1
    v_cvt_pk_bf16_f32 v24, v24, v25
    v_mfma_f32_32x32x16_bf16 v[80:95], v[160:163], v[172:175], v[80:95]
    v_cvt_pk_bf16_f32 v25, v26, v27
    v_cvt_pk_bf16_f32 v26, v28, v29
    v_cvt_pk_bf16_f32 v27, v30, v31
    buffer_store_dwordx4 v[24:27], v205, s[52:55], s39 offen offset:1024 sc1
    s_nop 2
    v_cvt_pk_bf16_f32 v176, v64, v65
    v_cvt_pk_bf16_f32 v177, v66, v67
    v_cvt_pk_bf16_f32 v178, v72, v73
    v_cvt_pk_bf16_f32 v179, v74, v75
    buffer_store_dwordx4 v[176:179], v206, s[52:55], s38 offen offset:0 sc1
    v_cvt_pk_bf16_f32 v180, v68, v69
    v_cvt_pk_bf16_f32 v181, v70, v71
    v_cvt_pk_bf16_f32 v182, v76, v77
    v_cvt_pk_bf16_f32 v183, v78, v79
    buffer_store_dwordx4 v[180:183], v206, s[52:55], s38 offen offset:128 sc1
    v_cvt_pk_bf16_f32 v184, v80, v81
    v_cvt_pk_bf16_f32 v185, v82, v83
    v_cvt_pk_bf16_f32 v186, v88, v89
    v_cvt_pk_bf16_f32 v187, v90, v91
    buffer_store_dwordx4 v[184:187], v206, s[52:55], s15 offen offset:0 sc1
    v_cvt_pk_bf16_f32 v188, v84, v85
    v_cvt_pk_bf16_f32 v189, v86, v87
    v_cvt_pk_bf16_f32 v190, v92, v93
    v_cvt_pk_bf16_f32 v191, v94, v95
    buffer_store_dwordx4 v[188:191], v206, s[52:55], s15 offen offset:128 sc1
    s_barrier
    v_mov_b32 v227, 0
    s_waitcnt vmcnt(0)
    s_mov_b32 s35, 40000
L_tagc:
    v_readfirstlane_b32 s12, v253
    s_nop 3
    s_cmp_lg_u32 s12, 0
    s_cbranch_scc1 L_tagokc
    v_mov_b32 v227, 0
    global_load_dword v253, v227, s[30:31] sc1
    s_sub_u32 s35, s35, 1
    s_waitcnt vmcnt(0)
    s_cmp_lg_u32 s35, 0
    s_cbranch_scc1 L_tagc
L_tagokc:
    s_mov_b64 exec, 1
    buffer_store_dword v253, v227, s[52:55], s41 offen sc1
    s_mov_b64 exec, -1
    s_branch L_cmp2
L_cmp_idle:
    global_load_dword v253, v1, s[30:31] sc1
    s_waitcnt vmcnt(0)
    s_mov_b32 s35, 40000
L_tagi:
    v_readfirstlane_b32 s12, v253
    s_nop 3
    s_cmp_lg_u32 s12, 0
    s_cbranch_scc1 L_tagoki
    v_mov_b32 v227, 0
    global_load_dword v253, v227, s[30:31] sc1
    s_sub_u32 s35, s35, 1
    s_waitcnt vmcnt(0)
    s_cmp_lg_u32 s35, 0
    s_cbranch_scc1 L_tagi
L_tagoki:
L_cmp2:
    s_and_b32 s60, s4, 1
    s_lshr_b32 s61, s4, 1
    v_and_b32 v240, 15, v255
    v_lshrrev_b32 v241, 4, v255
    v_cmp_gt_u32 vcc, 48, v255
    s_nop 1
    v_cndmask_b32 v250, 0, -1, vcc
    v_lshrrev_b32 v220, 2, v240
    v_lshl_add_u32 v221, v241, 2, v220
    v_lshlrev_b32 v221, 7, v221
    s_mul_i32 s3, s61, 14336
    v_add_u32 v221, s3, v221
    v_and_b32 v222, 2, v220
    v_and_b32 v223, 1, v241
    v_lshl_or_b32 v222, v223, 2, v222
    v_lshlrev_b32 v222, 4, v222
    v_and_b32 v223, 3, v255
    v_lshlrev_b32 v224, 3, v223
    v_xor_b32 v222, v222, v224
    v_add_u32 v221, v221, v222
    v_and_b32 v222, 2048, v250
    s_add_u32 s3, s61, 0
    s_and_b32 s3, s3, 3
    s_lshl_b32 s3, s3, 5
    v_xor_b32 v242, s3, v221
    v_add_u32 v246, v242, v222
    s_add_u32 s3, s61, 1
    s_and_b32 s3, s3, 3
    s_lshl_b32 s3, s3, 5
    v_xor_b32 v243, s3, v221
    v_add_u32 v247, v243, v222
    s_add_u32 s3, s61, 2
    s_and_b32 s3, s3, 3
    s_lshl_b32 s3, s3, 5
    v_xor_b32 v244, s3, v221
    v_add_u32 v248, v244, v222
    s_add_u32 s3, s61, 3
    s_and_b32 s3, s3, 3
    s_lshl_b32 s3, s3, 5
    v_xor_b32 v245, s3, v221
    v_add_u32 v249, v245, v222
    v_mov_b32 v224, 1073741824
    v_lshlrev_b32 v232, 9, v241
    v_lshl_add_u32 v232, v240, 4, v232
    v_lshlrev_b32 v233, 6, v240
    v_lshl_add_u32 v233, v241, 4, v233
    v_lshlrev_b32 v234, 8, v220
    v_lshl_add_u32 v234, v241, 6, v234
    v_lshl_add_u32 v234, v223, 4, v234
    v_add_u32 v235, 1024, v234
    v_cmp_gt_u32 vcc, 12, v240
    s_nop 1
    v_cndmask_b32 v235, v224, v235, vcc
    v_cmp_eq_u32 vcc, 12, v240
    v_mov_b32 v224, 0x3f803f80
    s_nop 0
    v_cndmask_b32 v236, 0, v224, vcc
    v_mov_b32 v252, 1049335798
    v_mov_b32 v237, 4048155338
    s_and_b32 s3, s4, 6
    s_lshl_b32 s3, s3, 10
    s_add_u32 s3, s3, 114688
    v_add_u32 v239, s3, v254
    s_mul_i32 s3, s8, 7
    s_lshr_b32 s100, s3, 1
    s_lshl_b32 s100, s100, 9
    s_lshl_b32 s98, s3, 8
    v_cmp_lt_u32 vcc, 15, v255
    s_nop 1
    v_cndmask_b32 v220, 0, -1, vcc
    s_bitcmp1_b32 s8, 0
    s_cselect_b64 vcc, -1, 0
    v_cndmask_b32 v228, -1, v220, vcc
    v_cndmask_b32 v229, v250, -1, vcc
    s_mul_i32 s3, s4, 3
    s_lshl_b32 s62, s9, 3
    s_sub_u32 s62, s62, 16
    s_add_u32 s62, s62, s3
    s_lshl_b32 s3, s3, 10
    s_add_u32 s3, s3, 114688
    v_add_u32 v238, s3, v254
    v_subrev_u32 v220, 1024, v235
    s_bitcmp1_b32 s4, 0
    s_cselect_b64 vcc, -1, 0
    v_cndmask_b32 v251, v234, v220, vcc
    v_cndmask_b32 v226, v220, v234, vcc
    v_cndmask_b32 v230, 0, v236, vcc
    v_cndmask_b32 v231, v236, 0, vcc
    s_ashr_i32 s34, s62, 1
    s_mul_i32 s34, s34, 28672
    s_and_b32 s35, s62, 1
    s_lshl_b32 s3, s35, 10
    s_add_u32 s3, s3, s34
    s_add_u32 s3, s3, s98
    s_add_u32 s3, s3, 4194304
    s_lshl_b32 s35, s35, 8
    s_add_u32 s35, s35, s34
    s_add_u32 s35, s35, s100
    s_add_u32 s35, s35, 2097152
    s_cmp_lt_i32 s62, 0
    s_cselect_b32 s22, 1073741824, s3
    s_cselect_b32 s16, 1073741824, s35
    s_add_u32 s62, s62, 1
    s_ashr_i32 s34, s62, 1
    s_mul_i32 s34, s34, 28672
    s_and_b32 s35, s62, 1
    s_lshl_b32 s3, s35, 10
    s_add_u32 s3, s3, s34
    s_add_u32 s3, s3, s98
    s_add_u32 s3, s3, 4194304
    s_lshl_b32 s35, s35, 8
    s_add_u32 s35, s35, s34
    s_add_u32 s35, s35, s100
    s_add_u32 s35, s35, 2097152
    s_cmp_lt_i32 s62, 0
    s_cselect_b32 s23, 1073741824, s3
    s_cselect_b32 s17, 1073741824, s35
    s_add_u32 s62, s62, 1
    s_ashr_i32 s34, s62, 1
    s_mul_i32 s34, s34, 28672
    s_and_b32 s35, s62, 1
    s_lshl_b32 s3, s35, 10
    s_add_u32 s3, s3, s34
    s_add_u32 s3, s3, s98
    s_add_u32 s3, s3, 4194304
    s_lshl_b32 s35, s35, 8
    s_add_u32 s35, s35, s34
    s_add_u32 s35, s35, s100
    s_add_u32 s35, s35, 2097152
    s_cmp_lt_i32 s62, 0
    s_cselect_b32 s24, 1073741824, s3
    s_cselect_b32 s18, 1073741824, s35
    s_add_u32 s62, s62, 1
    s_lshl_b32 s3, s9, 3
    s_add_u32 s3, s3, s4
    s_lshr_b32 s34, s3, 1
    s_mul_i32 s34, s34, 28672
    s_and_b32 s35, s3, 1
    s_lshl_b32 s35, s35, 8
    s_add_u32 s35, s35, s34
    s_add_u32 s32, s35, s100
    s_lshl_b32 s3, s3, 4
    s_add_u32 s3, s3, s8
    s_lshl_b32 s3, s3, 10
    s_add_u32 s33, s3, 12582912
    s_mul_i32 s3, s8, 7
    s_lshr_b32 s34, s3, 3
    s_add_u32 s3, s3, 6
    s_lshr_b32 s35, s3, 3
    s_sub_u32 s35, s35, s34
    v_and_b32 v220, 1, v255
    v_mul_u32_u24 v220, s35, v220
    v_add_u32 v220, s34, v220
    v_min_u32 v221, 11, v255
    v_lshrrev_b32 v221, 1, v221
    s_lshl_b32 s3, s9, 1
    s_sub_u32 s3, s3, 4
    v_add_u32 v221, s3, v221
    v_max_i32 v221, 0, v221
    v_lshl_add_u32 v221, v221, 4, v220
    v_lshlrev_b32 v225, 7, v221
    s_lshl_b32 s3, s10, 2
    s_lshl_b32 s35, s60, 1
    s_add_u32 s3, s3, s35
    s_lshl_b32 s3, s3, 4
    s_lshl_b32 s35, s61, 2
    s_add_u32 s3, s3, s35
    s_lshl_b32 s3, s3, 10
    s_add_u32 s96, s3, 14680064
    s_add_u32 s97, s96, 16384
    s_add_u32 s28, s3, 12582912
    s_add_u32 s29, s28, 16384
    s_mov_b32 s15, 16777216
    s_branch L_phase2
L_brB:
    s_and_b32 s15, s13, 1
    s_lshl_b32 s15, s15, 2
    s_and_b32 s3, s14, 3
    s_add_u32 s6, s15, s3
    s_and_b32 s15, s13, 2
    s_lshl_b32 s15, s15, 2
    s_lshr_b32 s3, s14, 2
    s_add_u32 s7, s15, s3
    s_cmp_lt_u32 s4, 4
    s_cbranch_scc1 L_cmpB
    s_sub_u32 s96, s4, 4
    s_lshl_b32 s34, s7, 7
    s_lshl_b32 s35, s96, 5
    s_add_u32 s34, s34, s35
    v_add_u32 v4, s34, v1
    v_mul_u32_u24 v4, 896, v4
    v_xor_b32 v5, v2, v3
    v_lshl_add_u32 v10, v5, 4, v4
    v_xor_b32 v5, 4, v5
    v_lshl_add_u32 v11, v5, 4, v4
    v_add_u32 v11, 6144, v11
    s_lshl_b32 s97, s96, 12
    s_lshl_b32 s101, s96, 11
    s_lshl_b32 s63, s96, 9
    s_lshl_b32 s35, s96, 4
    v_add_u32 v4, s35, v1
    v_mul_u32_u24 v4, 2688, v4
    s_mul_i32 s35, s6, 112
    v_add_u32 v4, s35, v4
    v_and_b32 v5, 1, v3
    v_lshlrev_b32 v5, 1, v5
    v_xor_b32 v5, v2, v5
    v_mov_b32 v7, 1073741824
    v_lshl_add_u32 v13, v5, 4, v4
    v_cmp_eq_u32 vcc, 7, v5
    v_xor_b32 v6, 4, v5
    s_nop 0
    v_cndmask_b32 v13, v13, v7, vcc
    v_lshl_add_u32 v14, v6, 4, v4
    v_cmp_eq_u32 vcc, 7, v6
    v_add_u32 v14, 20480, v14
    s_nop 0
    v_cndmask_b32 v14, v14, v7, vcc
    s_lshl_b32 s34, s7, 7
    s_lshl_b32 s35, s96, 2
    s_add_u32 s34, s34, s35
    s_sub_u32 s34, s34, 16
    v_add_u32 v4, s34, v1
    v_mul_i32_i24 v4, 896, v4
    s_lshl_b32 s35, s96, 1
    v_add_u32 v5, s35, v3
    v_and_b32 v5, 7, v5
    v_xor_b32 v5, v2, v5
    v_lshl_add_u32 v12, v5, 4, v4
    s_cmp_eq_u32 s7, 0
    s_cselect_b64 vcc, -1, 0
    v_cndmask_b32 v12, v12, v7, vcc
    s_mov_b32 s38, 1835008
    s_mov_b32 s39, 0x20000
    s_mov_b32 s42, 1204224
    s_mov_b32 s43, 0x20000
    s_waitcnt lgkmcnt(0)
    s_mov_b32 s36, s22
    s_mov_b32 s37, s23
    s_mov_b32 s40, s24
    s_mov_b32 s41, s25
    s_add_u32 m0, s97, 122880
    s_mov_b32 s34, 0
    s_mov_b32 s35, 12288
    buffer_load_dwordx4 v10, s[36:39], s34 offen lds
    buffer_load_dwordx4 v11, s[36:39], s34 offen offset:1024 lds
    buffer_load_dwordx4 v10, s[36:39], s35 offen offset:2048 lds
    buffer_load_dwordx4 v11, s[36:39], s35 offen offset:3072 lds
    s_add_u32 m0, s101, 139264
    s_mov_b32 s35, 0
    buffer_load_dwordx4 v13, s[40:43], s35 offen lds
    buffer_load_dwordx4 v14, s[40:43], s35 offen offset:1024 lds
    s_add_u32 m0, s101, 147456
    s_mov_b32 s35, 896
    buffer_load_dwordx4 v13, s[40:43], s35 offen lds
    buffer_load_dwordx4 v14, s[40:43], s35 offen offset:1024 lds
    s_add_u32 m0, s101, 155648
    s_mov_b32 s35, 1792
    buffer_load_dwordx4 v13, s[40:43], s35 offen lds
    buffer_load_dwordx4 v14, s[40:43], s35 offen offset:1024 lds
    s_add_u32 m0, s63, 120832
    s_mov_b64 exec, 0xffffffff
    buffer_load_dwordx4 v12, s[36:39], s34 offen lds
    s_mov_b64 exec, -1
    s_and_b32 s34, s13, 2
    s_lshl_b32 s34, s34, 9
    s_lshl_b32 s35, s14, 5
    s_add_u32 s34, s34, s35
    v_min_u32 v4, 31, v255
    v_add_u32 v4, s34, v4
    v_mul_u32_u24 v16, 896, v4
    v_min_u32 v4, 23, v255
    v_cmp_le_u32 vcc, 12, v4
    s_nop 1
    v_cndmask_b32 v5, 0, 1, vcc
    v_mul_u32_u24 v6, 12, v5
    v_sub_u32 v6, v4, v6
    s_lshl_b32 s34, s14, 1
    v_add_u32 v5, s34, v5
    v_mul_u32_u24 v5, 2688, v5
    v_lshrrev_b32 v4, 2, v6
    v_mul_u32_u24 v4, 896, v4
    v_add_u32 v5, v5, v4
    v_and_b32 v6, 3, v6
    v_lshl_add_u32 v5, v6, 7, v5
    s_and_b32 s34, s13, 1
    s_mul_i32 s34, s34, 384
    v_add_u32 v5, s34, v5
    s_bitcmp1_b32 s96, 0
    s_cselect_b64 vcc, -1, 0
    s_mov_b32 s60, 128
    s_cselect_b32 s60, 172032, s60
    s_cselect_b32 s44, s40, s36
    s_cselect_b32 s45, s41, s37
    s_cselect_b32 s46, s42, s38
    s_mov_b32 s47, 0x20000
    v_cndmask_b32 v16, v16, v5, vcc
    s_lshr_b32 s61, s96, 1
    s_add_u32 s61, s61, 1
    s_mul_i32 s61, s61, s60
    s_lshl_b32 s60, s60, 1
    buffer_load_dword v20, v16, s[44:47], s61 offen
    s_add_u32 s61, s61, s60
    s_add_u32 m0, s97, 36864
    s_mov_b32 s34, 128
    s_mov_b32 s35, 12416
    buffer_load_dwordx4 v10, s[36:39], s34 offen lds
    buffer_load_dwordx4 v11, s[36:39], s34 offen offset:1024 lds
    buffer_load_dwordx4 v10, s[36:39], s35 offen offset:2048 lds
    buffer_load_dwordx4 v11, s[36:39], s35 offen offset:3072 lds
    s_add_u32 m0, s101, 53248
    s_mov_b32 s35, 172032
    buffer_load_dwordx4 v13, s[40:43], s35 offen lds
    buffer_load_dwordx4 v14, s[40:43], s35 offen offset:1024 lds
    s_add_u32 m0, s101, 61440
    s_mov_b32 s35, 172928
    buffer_load_dwordx4 v13, s[40:43], s35 offen lds
    buffer_load_dwordx4 v14, s[40:43], s35 offen offset:1024 lds
    s_add_u32 m0, s101, 69632
    s_mov_b32 s35, 173824
    buffer_load_dwordx4 v13, s[40:43], s35 offen lds
    buffer_load_dwordx4 v14, s[40:43], s35 offen offset:1024 lds
    s_add_u32 m0, s63, 34816
    s_mov_b64 exec, 0xffffffff
    buffer_load_dwordx4 v12, s[36:39], s34 offen lds
    s_mov_b64 exec, -1
    s_waitcnt vmcnt(12)
    s_barrier
    buffer_load_dword v20, v16, s[44:47], s61 offen
    s_add_u32 s61, s61, s60
    s_add_u32 m0, s97, 79872
    s_mov_b32 s34, 256
    s_mov_b32 s35, 12544
    buffer_load_dwordx4 v10, s[36:39], s34 offen lds
    buffer_load_dwordx4 v11, s[36:39], s34 offen offset:1024 lds
    buffer_load_dwordx4 v10, s[36:39], s35 offen offset:2048 lds
    buffer_load_dwordx4 v11, s[36:39], s35 offen offset:3072 lds
    s_add_u32 m0, s101, 96256
    s_mov_b32 s35, 344064
    buffer_load_dwordx4 v13, s[40:43], s35 offen lds
    buffer_load_dwordx4 v14, s[40:43], s35 offen offset:1024 lds
    s_add_u32 m0, s101, 104448
    s_mov_b32 s35, 344960
    buffer_load_dwordx4 v13, s[40:43], s35 offen lds
    buffer_load_dwordx4 v14, s[40:43], s35 offen offset:1024 lds
    s_add_u32 m0, s101, 112640
    s_mov_b32 s35, 345856
    buffer_load_dwordx4 v13, s[40:43], s35 offen lds
    buffer_load_dwordx4 v14, s[40:43], s35 offen offset:1024 lds
    s_add_u32 m0, s63, 77824
    s_mov_b64 exec, 0xffffffff
    buffer_load_dwordx4 v12, s[36:39], s34 offen lds
    s_mov_b64 exec, -1
    s_waitcnt vmcnt(12)
    s_barrier
    buffer_load_dword v20, v16, s[44:47], s61 offen
    s_add_u32 s61, s61, s60
    s_add_u32 m0, s97, 122880
    s_mov_b32 s34, 384
    s_mov_b32 s35, 12672
    buffer_load_dwordx4 v10, s[36:39], s34 offen lds
    buffer_load_dwordx4 v11, s[36:39], s34 offen offset:1024 lds
    buffer_load_dwordx4 v10, s[36:39], s35 offen offset:2048 lds
    buffer_load_dwordx4 v11, s[36:39], s35 offen offset:3072 lds
    s_add_u32 m0, s101, 139264
    s_mov_b32 s35, 516096
    buffer_load_dwordx4 v13, s[40:43], s35 offen lds
    buffer_load_dwordx4 v14, s[40:43], s35 offen offset:1024 lds
    s_add_u32 m0, s101, 147456
    s_mov_b32 s35, 516992
    buffer_load_dwordx4 v13, s[40:43], s35 offen lds
    buffer_load_dwordx4 v14, s[40:43], s35 offen offset:1024 lds
    s_add_u32 m0, s101, 155648
    s_mov_b32 s35, 517888
    buffer_load_dwordx4 v13, s[40:43], s35 offen lds
    buffer_load_dwordx4 v14, s[40:43], s35 offen offset:1024 lds
    s_add_u32 m0, s63, 120832
    s_mov_b64 exec, 0xffffffff
    buffer_load_dwordx4 v12, s[36:39], s34 offen lds
    s_mov_b64 exec, -1
    s_lshl_b32 s8, s13, 1
    s_and_b32 s3, s14, 1
    s_add_u32 s8, s8, s3
    s_lshr_b32 s9, s14, 1
    s_lshl_b32 s10, s13, 2
    s_lshr_b32 s3, s14, 3
    s_add_u32 s10, s10, s3
    s_and_b32 s11, s14, 7
    s_mov_b32 s44, s20
    s_mov_b32 s45, s21
    s_mov_b32 s46, 401408
    s_mov_b32 s47, 0x20000
    s_mov_b32 s48, s26
    s_mov_b32 s49, s27
    s_mov_b32 s50, 401408
    s_mov_b32 s51, 0x20000
    s_mov_b32 s52, s32
    s_mov_b32 s53, s33
    s_mov_b32 s54, 18874368
    s_mov_b32 s55, 0x20000
    s_mov_b32 s56, s28
    s_mov_b32 s57, s29
    s_mov_b32 s58, 3670016
    s_mov_b32 s59, 0x20000
    v_and_b32 v5, 6, v1
    v_xor_b32 v5, v2, v5
    v_mul_u32_u24 v4, 896, v1
    s_lshl_b32 s35, s11, 7
    v_add_u32 v4, s35, v4
    v_lshl_add_u32 v15, v5, 4, v4
    s_cmp_eq_u32 s11, 7
    s_cselect_b64 vcc, -1, 0
    v_mov_b32 v7, 1073741824
    v_cndmask_b32 v15, v15, v7, vcc
    v_mov_b32 v1, 0
    s_mul_i32 s3, s14, 98
    s_and_b32 s35, s96, 1
    s_mul_i32 s35, s35, 49
    s_add_u32 s3, s3, s35
    v_min_u32 v4, 48, v255
    v_add_u32 v4, s3, v4
    v_lshlrev_b32 v17, 7, v4
    s_mul_i32 s14, s96, 7168
    s_lshl_b32 s15, s96, 10
    global_load_dword v253, v1, s[30:31] sc1
    s_waitcnt vmcnt(13)
    s_barrier
    s_add_u32 m0, s97, 36864
    s_mov_b32 s34, 512
    s_mov_b32 s35, 12800
    buffer_load_dwordx4 v10, s[36:39], s34 offen lds
    buffer_load_dwordx4 v11, s[36:39], s34 offen offset:1024 lds
    buffer_load_dwordx4 v10, s[36:39], s35 offen offset:2048 lds
    buffer_load_dwordx4 v11, s[36:39], s35 offen offset:3072 lds
    s_add_u32 m0, s101, 53248
    s_mov_b32 s35, 688128
    buffer_load_dwordx4 v13, s[40:43], s35 offen lds
    buffer_load_dwordx4 v14, s[40:43], s35 offen offset:1024 lds
    s_add_u32 m0, s101, 61440
    s_mov_b32 s35, 689024
    buffer_load_dwordx4 v13, s[40:43], s35 offen lds
    buffer_load_dwordx4 v14, s[40:43], s35 offen offset:1024 lds
    s_add_u32 m0, s101, 69632
    s_mov_b32 s35, 689920
    buffer_load_dwordx4 v13, s[40:43], s35 offen lds
    buffer_load_dwordx4 v14, s[40:43], s35 offen offset:1024 lds
    s_add_u32 m0, s63, 34816
    s_mov_b64 exec, 0xffffffff
    buffer_load_dwordx4 v12, s[36:39], s34 offen lds
    s_mov_b64 exec, -1
    s_waitcnt vmcnt(12)
    s_barrier
    s_add_u32 m0, s97, 79872
    s_mov_b32 s34, 640
    s_mov_b32 s35, 12928
    buffer_load_dwordx4 v10, s[36:39], s34 offen lds
    buffer_load_dwordx4 v11, s[36:39], s34 offen offset:1024 lds
    buffer_load_dwordx4 v10, s[36:39], s35 offen offset:2048 lds
    buffer_load_dwordx4 v11, s[36:39], s35 offen offset:3072 lds
    s_add_u32 m0, s101, 96256
    s_mov_b32 s35, 860160
    buffer_load_dwordx4 v13, s[40:43], s35 offen lds
    buffer_load_dwordx4 v14, s[40:43], s35 offen offset:1024 lds
    s_add_u32 m0, s101, 104448
    s_mov_b32 s35, 861056
    buffer_load_dwordx4 v13, s[40:43], s35 offen lds
    buffer_load_dwordx4 v14, s[40:43], s35 offen offset:1024 lds
    s_add_u32 m0, s101, 112640
    s_mov_b32 s35, 861952
    buffer_load_dwordx4 v13, s[40:43], s35 offen lds
    buffer_load_dwordx4 v14, s[40:43], s35 offen offset:1024 lds
    s_add_u32 m0, s63, 77824
    s_mov_b64 exec, 0xffffffff
    buffer_load_dwordx4 v12, s[36:39], s34 offen lds
    s_mov_b64 exec, -1
    s_waitcnt vmcnt(11)
    s_barrier
    s_add_u32 m0, s97, 122880
    s_mov_b32 s34, 768
    s_mov_b32 s35, 13056
    buffer_load_dwordx4 v10, s[36:39], s34 offen lds
    buffer_load_dwordx4 v11, s[36:39], s34 offen offset:1024 lds
    buffer_load_dwordx4 v10, s[36:39], s35 offen offset:2048 lds
    buffer_load_dwordx4 v11, s[36:39], s35 offen offset:3072 lds
    s_add_u32 m0, s101, 139264
    s_mov_b32 s35, 1032192
    buffer_load_dwordx4 v13, s[40:43], s35 offen lds
    buffer_load_dwordx4 v14, s[40:43], s35 offen offset:1024 lds
    s_add_u32 m0, s101, 147456
    s_mov_b32 s35, 1033088
    buffer_load_dwordx4 v13, s[40:43], s35 offen lds
    buffer_load_dwordx4 v14, s[40:43], s35 offen offset:1024 lds
    s_add_u32 m0, s101, 155648
    s_mov_b32 s35, 1033984
    buffer_load_dwordx4 v13, s[40:43], s35 offen lds
    buffer_load_dwordx4 v14, s[40:43], s35 offen offset:1024 lds
    s_add_u32 m0, s63, 120832
    s_mov_b64 exec, 0xffffffff
    buffer_load_dwordx4 v12, s[36:39], s34 offen lds
    s_mov_b64 exec, -1
    s_cmp_lt_u32 s96, 2
    s_cbranch_scc1 L_pwB2
    buffer_load_dword v20, v17, s[44:47], 0 offen
    s_branch L_pwD2
L_pwB2:
    buffer_load_dword v20, v17, s[48:51], 0 offen
L_pwD2:
    s_waitcnt vmcnt(12)
    s_barrier
    s_add_u32 m0, s15, 0
    s_add_u32 s35, s14, 0
    buffer_load_dwordx4 v15, s[48:51], s35 offen lds
    s_add_u32 m0, s15, 4096
    s_add_u32 s35, s14, 28672
    buffer_load_dwordx4 v15, s[48:51], s35 offen lds
    s_add_u32 m0, s15, 8192
    s_add_u32 s35, s14, 57344
    buffer_load_dwordx4 v15, s[48:51], s35 offen lds
    s_add_u32 m0, s15, 12288
    s_add_u32 s35, s14, 86016
    buffer_load_dwordx4 v15, s[48:51], s35 offen lds
    s_add_u32 m0, s15, 16384
    s_add_u32 s35, s14, 114688
    buffer_load_dwordx4 v15, s[48:51], s35 offen lds
    s_add_u32 m0, s15, 20480
    s_add_u32 s35, s14, 143360
    buffer_load_dwordx4 v15, s[48:51], s35 offen lds
    s_add_u32 m0, s15, 24576
    s_add_u32 s35, s14, 172032
    buffer_load_dwordx4 v15, s[48:51], s35 offen lds
    s_add_u32 m0, s15, 28672
    s_add_u32 s35, s14, 200704
    buffer_load_dwordx4 v15, s[48:51], s35 offen lds
    s_add_u32 m0, s15, 32768
    s_add_u32 s35, s14, 229376
    buffer_load_dwordx4 v15, s[48:51], s35 offen lds
    s_add_u32 m0, s15, 36864
    s_add_u32 s35, s14, 258048
    buffer_load_dwordx4 v15, s[48:51], s35 offen lds
    s_waitcnt vmcnt(11)
    s_barrier
    s_add_u32 m0, s15, 40960
    s_add_u32 s35, s14, 286720
    buffer_load_dwordx4 v15, s[48:51], s35 offen lds
    s_add_u32 m0, s15, 45056
    s_add_u32 s35, s14, 315392
    buffer_load_dwordx4 v15, s[48:51], s35 offen lds
    s_add_u32 m0, s15, 49152
    s_add_u32 s35, s14, 344064
    buffer_load_dwordx4 v15, s[48:51], s35 offen lds
    s_add_u32 m0, s15, 53248
    s_add_u32 s35, s14, 372736
    buffer_load_dwordx4 v15, s[48:51], s35 offen lds
    s_add_u32 m0, s15, 57344
    s_add_u32 s35, s14, 0
    buffer_load_dwordx4 v15, s[44:47], s35 offen lds
    s_add_u32 m0, s15, 61440
    s_add_u32 s35, s14, 28672
    buffer_load_dwordx4 v15, s[44:47], s35 offen lds
    s_add_u32 m0, s15, 65536
    s_add_u32 s35, s14, 57344
    buffer_load_dwordx4 v15, s[44:47], s35 offen lds
    s_add_u32 m0, s15, 69632
    s_add_u32 s35, s14, 86016
    buffer_load_dwordx4 v15, s[44:47], s35 offen lds
    s_add_u32 m0, s15, 73728
    s_add_u32 s35, s14, 114688
    buffer_load_dwordx4 v15, s[44:47], s35 offen lds
    s_add_u32 m0, s15, 77824
    s_add_u32 s35, s14, 143360
    buffer_load_dwordx4 v15, s[44:47], s35 offen lds
    s_branch L_ld2
L_cmpB:
    s_and_b32 s96, s4, 1
    s_lshr_b32 s97, s4, 1
    v_and_b32 v2, 15, v255
    s_lshl_b32 s3, s97, 6
    v_add_u32 v4, s3, v2
    v_lshlrev_b32 v4, 7, v4
    v_lshrrev_b32 v5, 1, v2
    v_xor_b32 v5, v5, v3
    v_lshl_add_u32 v200, v5, 4, v4
    v_add_u32 v200, 120832, v200
    v_xor_b32 v201, 64, v200
    v_lshrrev_b32 v4, 2, v2
    v_and_b32 v5, 3, v255
    v_lshl_add_u32 v6, v3, 3, v4
    v_lshlrev_b32 v6, 7, v6
    v_add_u32 v6, 139264, v6
    v_and_b32 v7, 2, v4
    v_and_b32 v8, 1, v3
    v_lshl_or_b32 v7, v8, 2, v7
    v_lshlrev_b32 v7, 4, v7
    s_mul_i32 s3, s96, 56
    v_lshl_add_u32 v8, v5, 3, s3
    v_xor_b32 v9, v8, v7
    v_add_u32 v202, v6, v9
    v_add_u32 v8, 32, v8
    v_cmp_eq_u32 vcc, 56, v8
    v_mov_b32 v9, 120
    s_nop 0
    v_cndmask_b32 v8, v8, v9, vcc
    v_xor_b32 v9, v8, v7
    v_add_u32 v203, v6, v9
    v_cmp_eq_u32 vcc, 12, v2
    s_nop 1
    v_cndmask_b32 v216, 0, 1.0, vcc
    v_mov_b32 v217, v216
    v_mov_b32 v218, v216
    v_mov_b32 v219, v216
    s_lshl_b32 s34, s7, 1
    s_add_u32 s34, s34, s97
    s_lshl_b32 s37, s34, 6
    s_lshl_b32 s3, s6, 1
    s_add_u32 s3, s3, s96
    s_add_u32 s3, s3, s37
    s_lshl_b32 s3, s3, 10
    s_add_u32 s36, s3, 14680064
    s_mov_b32 s37, s34
    v_mov_b32 v1, 0
    s_waitcnt lgkmcnt(0)
    s_or_b32 s3, s2, s4
    s_cmp_lg_u32 s3, 0
    s_cbranch_scc1 L_notag
    s_memrealtime s[34:35]
    s_waitcnt lgkmcnt(0)
    s_and_b32 s35, s34, 0x1fff
    s_lshl_b32 s35, s35, 1
    s_or_b32 s35, s35, 1
    s_bfe_u32 s3, s34, 0xf000d
    s_lshl_b32 s3, s3, 15
    s_or_b32 s35, s35, s3
    s_lshl_b32 s34, s34, 3
    s_and_b32 s34, s34, 0x80000000
    s_or_b32 s34, s34, s35
    v_mov_b32 v4, s34
    v_mov_b32 v5, 0
    s_mov_b64 exec, 1
    global_atomic_cmpswap v1, v[4:5], s[30:31] sc1
    s_mov_b64 exec, -1
L_notag:
    s_barrier
    ds_read_b128 v[116:119], v200 offset:2048
    ds_read_b128 v[120:123], v200 offset:4096
    ds_read_b128 v[124:127], v200 offset:6144
    ds_read_b128 v[128:131], v200 offset:8192
    ds_read_b128 v[112:115], v200 offset:0
    ds_read_b64_tr_b16 v[132:133], v202 offset:0
    ds_read_b64_tr_b16 v[134:135], v202 offset:512
    ds_read_b64_tr_b16 v[136:137], v203 offset:0
    ds_read_b64_tr_b16 v[138:139], v203 offset:512
    ds_read_b64_tr_b16 v[140:141], v202 offset:8192
    ds_read_b64_tr_b16 v[142:143], v202 offset:8704
    ds_read_b64_tr_b16 v[144:145], v203 offset:8192
    ds_read_b64_tr_b16 v[146:147], v203 offset:8704
    ds_read_b64_tr_b16 v[148:149], v202 offset:16384
    ds_read_b64_tr_b16 v[150:151], v202 offset:16896
    ds_read_b64_tr_b16 v[152:153], v203 offset:16384
    ds_read_b64_tr_b16 v[154:155], v203 offset:16896
    s_mov_b32 s42, 0
    s_waitcnt lgkmcnt(0)
    v_mfma_f32_16x16x32_bf16 v[0:3], v[132:135], v[116:119], 0
    ds_read_b128 v[160:163], v201 offset:2048
    v_mfma_f32_16x16x32_bf16 v[40:43], v[140:143], v[116:119], 0
    ds_read_b128 v[164:167], v201 offset:4096
    v_mfma_f32_16x16x32_bf16 v[80:83], v[116:119], v[148:151], 0
    ds_read_b128 v[168:171], v201 offset:6144
    v_mfma_f32_16x16x32_bf16 v[4:7], v[136:139], v[116:119], 0
    ds_read_b128 v[172:175], v201 offset:8192
    v_mfma_f32_16x16x32_bf16 v[44:47], v[144:147], v[116:119], 0
    ds_read_b128 v[156:159], v201 offset:0
    v_mfma_f32_16x16x32_bf16 v[84:87], v[116:119], v[152:155], v[216:219]
    ds_read_b64_tr_b16 v[176:177], v202 offset:4096
    v_mfma_f32_16x16x32_bf16 v[8:11], v[132:135], v[120:123], 0
    ds_read_b64_tr_b16 v[178:179], v202 offset:4608
    v_mfma_f32_16x16x32_bf16 v[48:51], v[140:143], v[120:123], 0
    ds_read_b64_tr_b16 v[180:181], v203 offset:4096
    v_mfma_f32_16x16x32_bf16 v[88:91], v[120:123], v[148:151], 0
    ds_read_b64_tr_b16 v[182:183], v203 offset:4608
    v_mfma_f32_16x16x32_bf16 v[12:15], v[136:139], v[120:123], 0
    ds_read_b64_tr_b16 v[184:185], v202 offset:12288
    v_mfma_f32_16x16x32_bf16 v[52:55], v[144:147], v[120:123], 0
    ds_read_b64_tr_b16 v[186:187], v202 offset:12800
    v_mfma_f32_16x16x32_bf16 v[92:95], v[120:123], v[152:155], v[216:219]
    ds_read_b64_tr_b16 v[188:189], v203 offset:12288
    v_mfma_f32_16x16x32_bf16 v[16:19], v[132:135], v[124:127], 0
    ds_read_b64_tr_b16 v[190:191], v203 offset:12800
    v_mfma_f32_16x16x32_bf16 v[56:59], v[140:143], v[124:127], 0
    ds_read_b64_tr_b16 v[192:193], v202 offset:20480
    v_mfma_f32_16x16x32_bf16 v[96:99], v[124:127], v[148:151], 0
    ds_read_b64_tr_b16 v[194:195], v202 offset:20992
    v_mfma_f32_16x16x32_bf16 v[20:23], v[136:139], v[124:127], 0
    ds_read_b64_tr_b16 v[196:197], v203 offset:20480
    v_mfma_f32_16x16x32_bf16 v[60:63], v[144:147], v[124:127], 0
    ds_read_b64_tr_b16 v[198:199], v203 offset:20992
    v_mfma_f32_16x16x32_bf16 v[100:103], v[124:127], v[152:155], v[216:219]
    v_mfma_f32_16x16x32_bf16 v[24:27], v[132:135], v[128:131], 0
    v_mfma_f32_16x16x32_bf16 v[64:67], v[140:143], v[128:131], 0
    v_mfma_f32_16x16x32_bf16 v[104:107], v[128:131], v[148:151], 0
    v_mfma_f32_16x16x32_bf16 v[28:31], v[136:139], v[128:131], 0
    v_mfma_f32_16x16x32_bf16 v[68:71], v[144:147], v[128:131], 0
    v_mfma_f32_16x16x32_bf16 v[108:111], v[128:131], v[152:155], v[216:219]
    v_mfma_f32_16x16x32_bf16 v[32:35], v[140:143], v[112:115], 0
    v_mfma_f32_16x16x32_bf16 v[72:75], v[112:115], v[148:151], 0
    v_mfma_f32_16x16x32_bf16 v[36:39], v[144:147], v[112:115], 0
    v_mfma_f32_16x16x32_bf16 v[76:79], v[112:115], v[152:155], v[216:219]
    s_lshl_b32 s8, s13, 1
    s_and_b32 s3, s14, 1
    s_add_u32 s8, s8, s3
    s_lshr_b32 s9, s14, 1
    s_lshl_b32 s10, s13, 2
    s_lshr_b32 s3, s14, 3
    s_add_u32 s10, s10, s3
    s_and_b32 s11, s14, 7
    s_mov_b32 s44, s20
    s_mov_b32 s45, s21
    s_mov_b32 s46, 401408
    s_mov_b32 s47, 0x20000
    s_mov_b32 s48, s26
    s_mov_b32 s49, s27
    s_mov_b32 s50, 401408
    s_mov_b32 s51, 0x20000
    s_mov_b32 s52, s32
    s_mov_b32 s53, s33
    s_mov_b32 s54, 18874368
    s_mov_b32 s55, 0x20000
    s_mov_b32 s56, s28
    s_mov_b32 s57, s29
    s_mov_b32 s58, 3670016
    s_mov_b32 s59, 0x20000
    v_mov_b32 v227, 0
    global_load_dword v253, v227, s[30:31] sc1
    v_mov_b32 v224, 4048155338
    v_and_b32 v220, 15, v255
    v_lshrrev_b32 v221, 4, v255
    v_lshlrev_b32 v221, 2, v221
    v_sub_u32 v220, v220, v221
    v_subrev_u32 v221, 0, v220
    v_and_b32 v222, 0x80000001, v221
    v_cmp_eq_u32 vcc, 0, v222
    s_nop 1
    v_cndmask_b32 v204, v224, 0, vcc
    v_cmp_eq_u32 vcc, 0x80000000, v222
    s_nop 1
    v_cndmask_b32 v208, v224, 0, vcc
    v_subrev_u32 v221, 1, v220
    v_and_b32 v222, 0x80000001, v221
    v_cmp_eq_u32 vcc, 0, v222
    s_nop 1
    v_cndmask_b32 v205, v224, 0, vcc
    v_cmp_eq_u32 vcc, 0x80000000, v222
    s_nop 1
    v_cndmask_b32 v209, v224, 0, vcc
    v_subrev_u32 v221, 2, v220
    v_and_b32 v222, 0x80000001, v221
    v_cmp_eq_u32 vcc, 0, v222
    s_nop 1
    v_cndmask_b32 v206, v224, 0, vcc
    v_cmp_eq_u32 vcc, 0x80000000, v222
    s_nop 1
    v_cndmask_b32 v210, v224, 0, vcc
    v_subrev_u32 v221, 3, v220
    v_and_b32 v222, 0x80000001, v221
    v_cmp_eq_u32 vcc, 0, v222
    s_nop 1
    v_cndmask_b32 v207, v224, 0, vcc
    v_cmp_eq_u32 vcc, 0x80000000, v222
    s_nop 1
    v_cndmask_b32 v211, v224, 0, vcc
    s_cmp_eq_u32 s37, 0
    s_cselect_b64 vcc, -1, 0
    v_cndmask_b32 v212, v208, v224, vcc
    v_cndmask_b32 v213, v209, v224, vcc
    v_cndmask_b32 v214, v210, v224, vcc
    v_cndmask_b32 v215, v211, v224, vcc
    s_and_b32 s60, s4, 1
    s_lshr_b32 s61, s4, 1
    v_and_b32 v240, 15, v255
    v_lshrrev_b32 v241, 4, v255
    v_cmp_gt_u32 vcc, 48, v255
    s_nop 1
    v_cndmask_b32 v250, 0, -1, vcc
    v_lshrrev_b32 v220, 2, v240
    v_lshl_add_u32 v221, v241, 2, v220
    v_lshlrev_b32 v221, 7, v221
    s_mul_i32 s3, s61, 14336
    v_add_u32 v221, s3, v221
    v_and_b32 v222, 2, v220
    v_and_b32 v223, 1, v241
    v_lshl_or_b32 v222, v223, 2, v222
    v_lshlrev_b32 v222, 4, v222
    v_and_b32 v223, 3, v255
    v_lshlrev_b32 v224, 3, v223
    v_xor_b32 v222, v222, v224
    v_add_u32 v221, v221, v222
    v_and_b32 v222, 2048, v250
    s_add_u32 s3, s61, 0
    s_and_b32 s3, s3, 3
    s_lshl_b32 s3, s3, 5
    v_xor_b32 v242, s3, v221
    v_add_u32 v246, v242, v222
    s_add_u32 s3, s61, 1
    s_and_b32 s3, s3, 3
    s_lshl_b32 s3, s3, 5
    v_xor_b32 v243, s3, v221
    v_add_u32 v247, v243, v222
    s_add_u32 s3, s61, 2
    s_and_b32 s3, s3, 3
    s_lshl_b32 s3, s3, 5
    v_xor_b32 v244, s3, v221
    v_add_u32 v248, v244, v222
    s_add_u32 s3, s61, 3
    s_and_b32 s3, s3, 3
    s_lshl_b32 s3, s3, 5
    v_xor_b32 v245, s3, v221
    v_add_u32 v249, v245, v222
    v_mov_b32 v224, 1073741824
    v_lshlrev_b32 v232, 9, v241
    v_lshl_add_u32 v232, v240, 4, v232
    v_lshlrev_b32 v233, 6, v240
    v_lshl_add_u32 v233, v241, 4, v233
    v_lshlrev_b32 v234, 8, v220
    v_lshl_add_u32 v234, v241, 6, v234
    v_lshl_add_u32 v234, v223, 4, v234
    v_add_u32 v235, 1024, v234
    v_cmp_gt_u32 vcc, 12, v240
    s_nop 1
    v_cndmask_b32 v235, v224, v235, vcc
    v_cmp_eq_u32 vcc, 12, v240
    v_mov_b32 v224, 0x3f803f80
    s_nop 0
    v_cndmask_b32 v236, 0, v224, vcc
    v_mov_b32 v252, 1049335798
    v_mov_b32 v237, 4048155338
    s_and_b32 s3, s4, 6
    s_lshl_b32 s3, s3, 10
    s_add_u32 s3, s3, 114688
    v_add_u32 v239, s3, v254
    s_mul_i32 s3, s8, 7
    s_lshr_b32 s100, s3, 1
    s_lshl_b32 s100, s100, 9
    s_lshl_b32 s98, s3, 8
    v_cmp_lt_u32 vcc, 15, v255
    s_nop 1
    v_cndmask_b32 v220, 0, -1, vcc
    s_bitcmp1_b32 s8, 0
    s_cselect_b64 vcc, -1, 0
    v_cndmask_b32 v228, -1, v220, vcc
    v_cndmask_b32 v229, v250, -1, vcc
    s_mul_i32 s3, s42, 86
    s_lshr_b32 s3, s3, 8
    s_mul_i32 s3, s3, 3
    s_cmp_eq_u32 s3, s42
    s_mov_b32 s43, 43008
    s_cselect_b32 s43, 4294881280, s43
    v_add_u32 v200, s43, v200
    v_add_u32 v201, s43, v201
    v_add_u32 v202, s43, v202
    v_add_u32 v203, s43, v203
    s_cmp_eq_u32 s42, 6
    s_waitcnt lgkmcnt(0)
    s_cbranch_scc1 L_nobarB0
    s_barrier
L_nobarB0:
    v_mfma_f32_16x16x32_bf16 v[0:3], v[176:179], v[160:163], v[0:3]
    ds_read_b128 v[116:119], v200 offset:2048
    v_mfma_f32_16x16x32_bf16 v[40:43], v[184:187], v[160:163], v[40:43]
    ds_read_b128 v[120:123], v200 offset:4096
    v_mfma_f32_16x16x32_bf16 v[80:83], v[160:163], v[192:195], v[80:83]
    ds_read_b128 v[124:127], v200 offset:6144
    v_mfma_f32_16x16x32_bf16 v[4:7], v[180:183], v[160:163], v[4:7]
    ds_read_b128 v[128:131], v200 offset:8192
    v_mfma_f32_16x16x32_bf16 v[44:47], v[188:191], v[160:163], v[44:47]
    ds_read_b128 v[112:115], v200 offset:0
    v_mfma_f32_16x16x32_bf16 v[84:87], v[160:163], v[196:199], v[84:87]
    ds_read_b64_tr_b16 v[132:133], v202 offset:0
    v_mfma_f32_16x16x32_bf16 v[8:11], v[176:179], v[164:167], v[8:11]
    ds_read_b64_tr_b16 v[134:135], v202 offset:512
    v_mfma_f32_16x16x32_bf16 v[48:51], v[184:187], v[164:167], v[48:51]
    ds_read_b64_tr_b16 v[136:137], v203 offset:0
    v_mfma_f32_16x16x32_bf16 v[88:91], v[164:167], v[192:195], v[88:91]
    ds_read_b64_tr_b16 v[138:139], v203 offset:512
    v_mfma_f32_16x16x32_bf16 v[12:15], v[180:183], v[164:167], v[12:15]
    ds_read_b64_tr_b16 v[140:141], v202 offset:8192
    v_mfma_f32_16x16x32_bf16 v[52:55], v[188:191], v[164:167], v[52:55]
    ds_read_b64_tr_b16 v[142:143], v202 offset:8704
    v_mfma_f32_16x16x32_bf16 v[92:95], v[164:167], v[196:199], v[92:95]
    ds_read_b64_tr_b16 v[144:145], v203 offset:8192
    v_mfma_f32_16x16x32_bf16 v[16:19], v[176:179], v[168:171], v[16:19]
    ds_read_b64_tr_b16 v[146:147], v203 offset:8704
    v_mfma_f32_16x16x32_bf16 v[56:59], v[184:187], v[168:171], v[56:59]
    ds_read_b64_tr_b16 v[148:149], v202 offset:16384
    v_mfma_f32_16x16x32_bf16 v[96:99], v[168:171], v[192:195], v[96:99]
    ds_read_b64_tr_b16 v[150:151], v202 offset:16896
    v_mfma_f32_16x16x32_bf16 v[20:23], v[180:183], v[168:171], v[20:23]
    ds_read_b64_tr_b16 v[152:153], v203 offset:16384
    v_mfma_f32_16x16x32_bf16 v[60:63], v[188:191], v[168:171], v[60:63]
    ds_read_b64_tr_b16 v[154:155], v203 offset:16896
    v_mfma_f32_16x16x32_bf16 v[100:103], v[168:171], v[196:199], v[100:103]
    v_mfma_f32_16x16x32_bf16 v[24:27], v[176:179], v[172:175], v[24:27]
    v_mfma_f32_16x16x32_bf16 v[64:67], v[184:187], v[172:175], v[64:67]
    v_mfma_f32_16x16x32_bf16 v[104:107], v[172:175], v[192:195], v[104:107]
    v_mfma_f32_16x16x32_bf16 v[28:31], v[180:183], v[172:175], v[28:31]
    v_mfma_f32_16x16x32_bf16 v[68:71], v[188:191], v[172:175], v[68:71]
    v_mfma_f32_16x16x32_bf16 v[108:111], v[172:175], v[196:199], v[108:111]
    v_mfma_f32_16x16x32_bf16 v[32:35], v[184:187], v[156:159], v[32:35]
    v_mfma_f32_16x16x32_bf16 v[72:75], v[156:159], v[192:195], v[72:75]
    v_mfma_f32_16x16x32_bf16 v[36:39], v[188:191], v[156:159], v[36:39]
    v_mfma_f32_16x16x32_bf16 v[76:79], v[156:159], v[196:199], v[76:79]
    s_mul_i32 s3, s4, 3
    s_lshl_b32 s62, s9, 3
    s_sub_u32 s62, s62, 16
    s_add_u32 s62, s62, s3
    s_lshl_b32 s3, s3, 10
    s_add_u32 s3, s3, 114688
    v_add_u32 v238, s3, v254
    v_subrev_u32 v220, 1024, v235
    s_bitcmp1_b32 s4, 0
    s_cselect_b64 vcc, -1, 0
    v_cndmask_b32 v251, v234, v220, vcc
    v_cndmask_b32 v226, v220, v234, vcc
    v_cndmask_b32 v230, 0, v236, vcc
    v_cndmask_b32 v231, v236, 0, vcc
    s_ashr_i32 s34, s62, 1
    s_mul_i32 s34, s34, 28672
    s_and_b32 s35, s62, 1
    s_lshl_b32 s3, s35, 10
    s_add_u32 s3, s3, s34
    s_add_u32 s3, s3, s98
    s_add_u32 s3, s3, 4194304
    s_lshl_b32 s35, s35, 8
    s_add_u32 s35, s35, s34
    s_add_u32 s35, s35, s100
    s_add_u32 s35, s35, 2097152
    s_cmp_lt_i32 s62, 0
    s_cselect_b32 s22, 1073741824, s3
    s_cselect_b32 s16, 1073741824, s35
    s_add_u32 s62, s62, 1
    s_ashr_i32 s34, s62, 1
    s_mul_i32 s34, s34, 28672
    s_and_b32 s35, s62, 1
    s_lshl_b32 s3, s35, 10
    s_add_u32 s3, s3, s34
    s_add_u32 s3, s3, s98
    s_add_u32 s3, s3, 4194304
    s_lshl_b32 s35, s35, 8
    s_add_u32 s35, s35, s34
    s_add_u32 s35, s35, s100
    s_add_u32 s35, s35, 2097152
    s_cmp_lt_i32 s62, 0
    s_cselect_b32 s23, 1073741824, s3
    s_cselect_b32 s17, 1073741824, s35
    s_add_u32 s62, s62, 1
    s_ashr_i32 s34, s62, 1
    s_mul_i32 s34, s34, 28672
    s_and_b32 s35, s62, 1
    s_lshl_b32 s3, s35, 10
    s_add_u32 s3, s3, s34
    s_add_u32 s3, s3, s98
    s_add_u32 s3, s3, 4194304
    s_lshl_b32 s35, s35, 8
    s_add_u32 s35, s35, s34
    s_add_u32 s35, s35, s100
    s_add_u32 s35, s35, 2097152
    s_cmp_lt_i32 s62, 0
    s_cselect_b32 s24, 1073741824, s3
    s_cselect_b32 s18, 1073741824, s35
    s_add_u32 s62, s62, 1
    s_lshl_b32 s3, s9, 3
    s_add_u32 s3, s3, s4
    s_lshr_b32 s34, s3, 1
    s_mul_i32 s34, s34, 28672
    s_and_b32 s35, s3, 1
    s_lshl_b32 s35, s35, 8
    s_add_u32 s35, s35, s34
    s_add_u32 s32, s35, s100
    s_lshl_b32 s3, s3, 4
    s_add_u32 s3, s3, s8
    s_lshl_b32 s3, s3, 10
    s_add_u32 s33, s3, 12582912
    s_mul_i32 s3, s8, 7
    s_lshr_b32 s34, s3, 3
    s_add_u32 s3, s3, 6
    s_lshr_b32 s35, s3, 3
    s_sub_u32 s35, s35, s34
    v_and_b32 v220, 1, v255
    v_mul_u32_u24 v220, s35, v220
    v_add_u32 v220, s34, v220
    v_min_u32 v221, 11, v255
    v_lshrrev_b32 v221, 1, v221
    s_lshl_b32 s3, s9, 1
    s_sub_u32 s3, s3, 4
    v_add_u32 v221, s3, v221
    v_max_i32 v221, 0, v221
    v_lshl_add_u32 v221, v221, 4, v220
    v_lshlrev_b32 v225, 7, v221
    s_lshl_b32 s3, s10, 2
    s_lshl_b32 s35, s60, 1
    s_add_u32 s3, s3, s35
    s_lshl_b32 s3, s3, 4
    s_lshl_b32 s35, s61, 2
    s_add_u32 s3, s3, s35
    s_lshl_b32 s3, s3, 10
    s_add_u32 s96, s3, 14680064
    s_add_u32 s97, s96, 16384
    s_add_u32 s28, s3, 12582912
    s_add_u32 s29, s28, 16384
    s_mov_b32 s15, 16777216
    s_mov_b32 s42, 1
L_gemmB:
    s_waitcnt lgkmcnt(0)
    v_mfma_f32_16x16x32_bf16 v[0:3], v[132:135], v[116:119], v[0:3]
    ds_read_b128 v[160:163], v201 offset:2048
    v_mfma_f32_16x16x32_bf16 v[40:43], v[140:143], v[116:119], v[40:43]
    ds_read_b128 v[164:167], v201 offset:4096
    v_mfma_f32_16x16x32_bf16 v[80:83], v[116:119], v[148:151], v[80:83]
    ds_read_b128 v[168:171], v201 offset:6144
    v_mfma_f32_16x16x32_bf16 v[4:7], v[136:139], v[116:119], v[4:7]
    ds_read_b128 v[172:175], v201 offset:8192
    v_mfma_f32_16x16x32_bf16 v[44:47], v[144:147], v[116:119], v[44:47]
    ds_read_b128 v[156:159], v201 offset:0
    v_mfma_f32_16x16x32_bf16 v[84:87], v[116:119], v[152:155], v[84:87]
    ds_read_b64_tr_b16 v[176:177], v202 offset:4096
    v_mfma_f32_16x16x32_bf16 v[8:11], v[132:135], v[120:123], v[8:11]
    ds_read_b64_tr_b16 v[178:179], v202 offset:4608
    v_mfma_f32_16x16x32_bf16 v[48:51], v[140:143], v[120:123], v[48:51]
    ds_read_b64_tr_b16 v[180:181], v203 offset:4096
    v_mfma_f32_16x16x32_bf16 v[88:91], v[120:123], v[148:151], v[88:91]
    ds_read_b64_tr_b16 v[182:183], v203 offset:4608
    v_mfma_f32_16x16x32_bf16 v[12:15], v[136:139], v[120:123], v[12:15]
    ds_read_b64_tr_b16 v[184:185], v202 offset:12288
    v_mfma_f32_16x16x32_bf16 v[52:55], v[144:147], v[120:123], v[52:55]
    ds_read_b64_tr_b16 v[186:187], v202 offset:12800
    v_mfma_f32_16x16x32_bf16 v[92:95], v[120:123], v[152:155], v[92:95]
    ds_read_b64_tr_b16 v[188:189], v203 offset:12288
    v_mfma_f32_16x16x32_bf16 v[16:19], v[132:135], v[124:127], v[16:19]
    ds_read_b64_tr_b16 v[190:191], v203 offset:12800
    v_mfma_f32_16x16x32_bf16 v[56:59], v[140:143], v[124:127], v[56:59]
    ds_read_b64_tr_b16 v[192:193], v202 offset:20480
    v_mfma_f32_16x16x32_bf16 v[96:99], v[124:127], v[148:151], v[96:99]
    ds_read_b64_tr_b16 v[194:195], v202 offset:20992
    v_mfma_f32_16x16x32_bf16 v[20:23], v[136:139], v[124:127], v[20:23]
    ds_read_b64_tr_b16 v[196:197], v203 offset:20480
    v_mfma_f32_16x16x32_bf16 v[60:63], v[144:147], v[124:127], v[60:63]
    ds_read_b64_tr_b16 v[198:199], v203 offset:20992
    v_mfma_f32_16x16x32_bf16 v[100:103], v[124:127], v[152:155], v[100:103]
    v_mfma_f32_16x16x32_bf16 v[24:27], v[132:135], v[128:131], v[24:27]
    v_mfma_f32_16x16x32_bf16 v[64:67], v[140:143], v[128:131], v[64:67]
    v_mfma_f32_16x16x32_bf16 v[104:107], v[128:131], v[148:151], v[104:107]
    v_mfma_f32_16x16x32_bf16 v[28:31], v[136:139], v[128:131], v[28:31]
    v_mfma_f32_16x16x32_bf16 v[68:71], v[144:147], v[128:131], v[68:71]
    v_mfma_f32_16x16x32_bf16 v[108:111], v[128:131], v[152:155], v[108:111]
    v_mfma_f32_16x16x32_bf16 v[32:35], v[140:143], v[112:115], v[32:35]
    v_mfma_f32_16x16x32_bf16 v[72:75], v[112:115], v[148:151], v[72:75]
    v_mfma_f32_16x16x32_bf16 v[36:39], v[144:147], v[112:115], v[36:39]
    v_mfma_f32_16x16x32_bf16 v[76:79], v[112:115], v[152:155], v[76:79]
    s_mul_i32 s3, s42, 86
    s_lshr_b32 s3, s3, 8
    s_mul_i32 s3, s3, 3
    s_cmp_eq_u32 s3, s42
    s_mov_b32 s43, 43008
    s_cselect_b32 s43, 4294881280, s43
    v_add_u32 v200, s43, v200
    v_add_u32 v201, s43, v201
    v_add_u32 v202, s43, v202
    v_add_u32 v203, s43, v203
    s_cmp_eq_u32 s42, 6
    s_waitcnt lgkmcnt(0)
    s_cbranch_scc1 L_nobarB
    s_barrier
L_nobarB:
    v_mfma_f32_16x16x32_bf16 v[0:3], v[176:179], v[160:163], v[0:3]
    ds_read_b128 v[116:119], v200 offset:2048
    v_mfma_f32_16x16x32_bf16 v[40:43], v[184:187], v[160:163], v[40:43]
    ds_read_b128 v[120:123], v200 offset:4096
    v_mfma_f32_16x16x32_bf16 v[80:83], v[160:163], v[192:195], v[80:83]
    ds_read_b128 v[124:127], v200 offset:6144
    v_mfma_f32_16x16x32_bf16 v[4:7], v[180:183], v[160:163], v[4:7]
    ds_read_b128 v[128:131], v200 offset:8192
    v_mfma_f32_16x16x32_bf16 v[44:47], v[188:191], v[160:163], v[44:47]
    ds_read_b128 v[112:115], v200 offset:0
    v_mfma_f32_16x16x32_bf16 v[84:87], v[160:163], v[196:199], v[84:87]
    ds_read_b64_tr_b16 v[132:133], v202 offset:0
    v_mfma_f32_16x16x32_bf16 v[8:11], v[176:179], v[164:167], v[8:11]
    ds_read_b64_tr_b16 v[134:135], v202 offset:512
    v_mfma_f32_16x16x32_bf16 v[48:51], v[184:187], v[164:167], v[48:51]
    ds_read_b64_tr_b16 v[136:137], v203 offset:0
    v_mfma_f32_16x16x32_bf16 v[88:91], v[164:167], v[192:195], v[88:91]
    ds_read_b64_tr_b16 v[138:139], v203 offset:512
    v_mfma_f32_16x16x32_bf16 v[12:15], v[180:183], v[164:167], v[12:15]
    ds_read_b64_tr_b16 v[140:141], v202 offset:8192
    v_mfma_f32_16x16x32_bf16 v[52:55], v[188:191], v[164:167], v[52:55]
    ds_read_b64_tr_b16 v[142:143], v202 offset:8704
    v_mfma_f32_16x16x32_bf16 v[92:95], v[164:167], v[196:199], v[92:95]
    ds_read_b64_tr_b16 v[144:145], v203 offset:8192
    v_mfma_f32_16x16x32_bf16 v[16:19], v[176:179], v[168:171], v[16:19]
    ds_read_b64_tr_b16 v[146:147], v203 offset:8704
    v_mfma_f32_16x16x32_bf16 v[56:59], v[184:187], v[168:171], v[56:59]
    ds_read_b64_tr_b16 v[148:149], v202 offset:16384
    v_mfma_f32_16x16x32_bf16 v[96:99], v[168:171], v[192:195], v[96:99]
    ds_read_b64_tr_b16 v[150:151], v202 offset:16896
    v_mfma_f32_16x16x32_bf16 v[20:23], v[180:183], v[168:171], v[20:23]
    ds_read_b64_tr_b16 v[152:153], v203 offset:16384
    v_mfma_f32_16x16x32_bf16 v[60:63], v[188:191], v[168:171], v[60:63]
    ds_read_b64_tr_b16 v[154:155], v203 offset:16896
    v_mfma_f32_16x16x32_bf16 v[100:103], v[168:171], v[196:199], v[100:103]
    v_mfma_f32_16x16x32_bf16 v[24:27], v[176:179], v[172:175], v[24:27]
    v_mfma_f32_16x16x32_bf16 v[64:67], v[184:187], v[172:175], v[64:67]
    v_mfma_f32_16x16x32_bf16 v[104:107], v[172:175], v[192:195], v[104:107]
    v_mfma_f32_16x16x32_bf16 v[28:31], v[180:183], v[172:175], v[28:31]
    v_mfma_f32_16x16x32_bf16 v[68:71], v[188:191], v[172:175], v[68:71]
    v_mfma_f32_16x16x32_bf16 v[108:111], v[172:175], v[196:199], v[108:111]
    v_mfma_f32_16x16x32_bf16 v[32:35], v[184:187], v[156:159], v[32:35]
    v_mfma_f32_16x16x32_bf16 v[72:75], v[156:159], v[192:195], v[72:75]
    v_mfma_f32_16x16x32_bf16 v[36:39], v[188:191], v[156:159], v[36:39]
    v_mfma_f32_16x16x32_bf16 v[76:79], v[156:159], v[196:199], v[76:79]
    s_add_u32 s42, s42, 1
    s_cmp_lt_u32 s42, 7
    s_cbranch_scc1 L_gemmB
    s_waitcnt vmcnt(0) lgkmcnt(0)
    s_mov_b32 s35, 40000
L_tagb:
    v_readfirstlane_b32 s12, v253
    s_nop 3
    s_cmp_lg_u32 s12, 0
    s_cbranch_scc1 L_tagokb
    v_mov_b32 v227, 0
    global_load_dword v253, v227, s[30:31] sc1
    s_sub_u32 s35, s35, 1
    s_waitcnt vmcnt(0)
    s_cmp_lg_u32 s35, 0
    s_cbranch_scc1 L_tagb
L_tagokb:
    v_cvt_pk_bf16_f32 v168, v0, v1
    v_cvt_pk_bf16_f32 v169, v2, v3
    v_cvt_pk_bf16_f32 v132, v40, v41
    v_cvt_pk_bf16_f32 v133, v42, v43
    v_cvt_pk_bf16_f32 v150, v80, v81
    v_cvt_pk_bf16_f32 v151, v82, v83
    v_cvt_pk_bf16_f32 v170, v4, v5
    v_cvt_pk_bf16_f32 v171, v6, v7
    v_cvt_pk_bf16_f32 v134, v44, v45
    v_cvt_pk_bf16_f32 v135, v46, v47
    v_cvt_pk_bf16_f32 v160, v84, v85
    v_cvt_pk_bf16_f32 v161, v86, v87
    v_cvt_pk_bf16_f32 v172, v8, v9
    v_cvt_pk_bf16_f32 v173, v10, v11
    v_cvt_pk_bf16_f32 v136, v48, v49
    v_cvt_pk_bf16_f32 v137, v50, v51
    v_cvt_pk_bf16_f32 v152, v88, v89
    v_cvt_pk_bf16_f32 v153, v90, v91
    v_cvt_pk_bf16_f32 v174, v12, v13
    v_cvt_pk_bf16_f32 v175, v14, v15
    v_cvt_pk_bf16_f32 v138, v52, v53
    v_cvt_pk_bf16_f32 v139, v54, v55
    v_cvt_pk_bf16_f32 v162, v92, v93
    v_cvt_pk_bf16_f32 v163, v94, v95
    v_cvt_pk_bf16_f32 v176, v16, v17
    v_cvt_pk_bf16_f32 v177, v18, v19
    v_cvt_pk_bf16_f32 v140, v56, v57
    v_cvt_pk_bf16_f32 v141, v58, v59
    v_cvt_pk_bf16_f32 v154, v96, v97
    v_cvt_pk_bf16_f32 v155, v98, v99
    v_cvt_pk_bf16_f32 v178, v20, v21
    v_cvt_pk_bf16_f32 v179, v22, v23
    v_cvt_pk_bf16_f32 v142, v60, v61
    v_cvt_pk_bf16_f32 v143, v62, v63
    v_cvt_pk_bf16_f32 v164, v100, v101
    v_cvt_pk_bf16_f32 v165, v102, v103
    v_cvt_pk_bf16_f32 v180, v24, v25
    v_cvt_pk_bf16_f32 v181, v26, v27
    v_cvt_pk_bf16_f32 v144, v64, v65
    v_cvt_pk_bf16_f32 v145, v66, v67
    v_cvt_pk_bf16_f32 v156, v104, v105
    v_cvt_pk_bf16_f32 v157, v106, v107
    v_cvt_pk_bf16_f32 v182, v28, v29
    v_cvt_pk_bf16_f32 v183, v30, v31
    v_cvt_pk_bf16_f32 v146, v68, v69
    v_cvt_pk_bf16_f32 v147, v70, v71
    v_cvt_pk_bf16_f32 v166, v108, v109
    v_cvt_pk_bf16_f32 v167, v110, v111
    v_cvt_pk_bf16_f32 v128, v32, v33
    v_cvt_pk_bf16_f32 v129, v34, v35
    v_cvt_pk_bf16_f32 v148, v72, v73
    v_cvt_pk_bf16_f32 v149, v74, v75
    v_cvt_pk_bf16_f32 v130, v36, v37
    v_cvt_pk_bf16_f32 v131, v38, v39
    v_cvt_pk_bf16_f32 v158, v76, v77
    v_cvt_pk_bf16_f32 v159, v78, v79
L_phase2:
    s_barrier
    s_cmp_lg_u32 s4, 7
    s_cbranch_scc1 L_pollok1
    s_mov_b32 s35, 40000
L_poll1:
    buffer_load_dword v9, v225, s[52:55], s15 offen sc1
    s_sub_u32 s35, s35, 1
    s_waitcnt vmcnt(0)
    v_cmp_ne_u32 vcc, v9, v253
    s_cmp_eq_u32 s35, 0
    s_cbranch_scc1 L_pollok1
    s_nop 1
    s_cbranch_vccz L_pollok1
    s_sleep 4
    s_branch L_poll1
L_pollok1:
    s_barrier
    buffer_load_dwordx4 v[72:75], v232, s[52:55], s16 offen sc1
    buffer_load_dwordx4 v[76:79], v232, s[52:55], s17 offen sc1
    buffer_load_dwordx4 v[80:83], v232, s[52:55], s18 offen sc1
    buffer_load_dwordx4 v[124:127], v232, s[52:55], s32 offen sc1
    buffer_load_dwordx4 v[84:87], v251, s[52:55], s22 offen sc1
    buffer_load_dwordx4 v[88:91], v226, s[52:55], s23 offen sc1
    buffer_load_dwordx4 v[92:95], v251, s[52:55], s24 offen sc1
    s_lshr_b32 s3, s4, 2
    s_cmp_gt_u32 s5, s3
    s_cbranch_scc0 L_noB1
    v_mfma_f32_16x16x32_bf16 v[0:3], v[128:131], v[168:171], v[212:215]
    v_mfma_f32_16x16x32_bf16 v[4:7], v[132:135], v[168:171], v[204:207]
    v_mfma_f32_16x16x32_bf16 v[8:11], v[132:135], v[172:175], v[208:211]
    v_mfma_f32_16x16x32_bf16 v[12:15], v[136:139], v[172:175], v[204:207]
    v_mfma_f32_16x16x32_bf16 v[16:19], v[136:139], v[176:179], v[208:211]
    v_mfma_f32_16x16x32_bf16 v[20:23], v[140:143], v[176:179], v[204:207]
    v_mfma_f32_16x16x32_bf16 v[24:27], v[140:143], v[180:183], v[208:211]
    v_mfma_f32_16x16x32_bf16 v[28:31], v[144:147], v[180:183], v[204:207]
    s_nop 0
    v_max3_f32 v32, v0, v1, v2
    v_max3_f32 v36, v3, v4, v5
    v_max3_f32 v32, v32, v6, v7
    v_max_f32 v32, v32, v36
    v_max3_f32 v33, v8, v9, v10
    v_max3_f32 v37, v11, v12, v13
    v_max3_f32 v33, v33, v14, v15
    v_max_f32 v33, v33, v37
    v_max3_f32 v34, v16, v17, v18
    v_max3_f32 v38, v19, v20, v21
    v_max3_f32 v34, v34, v22, v23
    v_max_f32 v34, v34, v38
    v_max3_f32 v35, v24, v25, v26
    v_max3_f32 v39, v27, v28, v29
    v_max3_f32 v35, v35, v30, v31
    v_max_f32 v35, v35, v39
    v_mov_b32 v36, v32
    v_mov_b32 v37, v33
    v_mov_b32 v38, v34
    v_mov_b32 v39, v35
    v_permlane32_swap_b32 v32, v36
    v_permlane32_swap_b32 v33, v37
    v_permlane32_swap_b32 v34, v38
    v_permlane32_swap_b32 v35, v39
    v_max_f32 v32, v32, v36
    v_max_f32 v33, v33, v37
    v_max_f32 v34, v34, v38
    v_max_f32 v35, v35, v39
    v_mov_b32 v36, v32
    v_mov_b32 v37, v33
    v_mov_b32 v38, v34
    v_mov_b32 v39, v35
    v_permlane16_swap_b32 v32, v36
    v_permlane16_swap_b32 v33, v37
    v_permlane16_swap_b32 v34, v38
    v_permlane16_swap_b32 v35, v39
    v_max_f32 v32, v32, v36
    v_max_f32 v33, v33, v37
    v_max_f32 v34, v34, v38
    v_max_f32 v35, v35, v39
    v_mul_f32 v32, v252, v32
    v_mul_f32 v33, v252, v33
    v_mul_f32 v34, v252, v34
    v_mul_f32 v35, v252, v35
    v_fma_f32 v0, v0, v252, -v32
    v_fma_f32 v1, v1, v252, -v32
    v_fma_f32 v2, v2, v252, -v32
    v_fma_f32 v3, v3, v252, -v32
    v_fma_f32 v4, v4, v252, -v32
    v_fma_f32 v5, v5, v252, -v32
    v_fma_f32 v6, v6, v252, -v32
    v_fma_f32 v7, v7, v252, -v32
    v_fma_f32 v8, v8, v252, -v33
    v_fma_f32 v9, v9, v252, -v33
    v_fma_f32 v10, v10, v252, -v33
    v_fma_f32 v11, v11, v252, -v33
    v_fma_f32 v12, v12, v252, -v33
    v_fma_f32 v13, v13, v252, -v33
    v_fma_f32 v14, v14, v252, -v33
    v_fma_f32 v15, v15, v252, -v33
    v_fma_f32 v16, v16, v252, -v34
    v_fma_f32 v17, v17, v252, -v34
    v_fma_f32 v18, v18, v252, -v34
    v_fma_f32 v19, v19, v252, -v34
    v_fma_f32 v20, v20, v252, -v34
    v_fma_f32 v21, v21, v252, -v34
    v_fma_f32 v22, v22, v252, -v34
    v_fma_f32 v23, v23, v252, -v34
    v_fma_f32 v24, v24, v252, -v35
    v_fma_f32 v25, v25, v252, -v35
    v_fma_f32 v26, v26, v252, -v35
    v_fma_f32 v27, v27, v252, -v35
    v_fma_f32 v28, v28, v252, -v35
    v_fma_f32 v29, v29, v252, -v35
    v_fma_f32 v30, v30, v252, -v35
    v_fma_f32 v31, v31, v252, -v35
    v_exp_f32 v0, v0
    v_exp_f32 v1, v1
    v_exp_f32 v2, v2
    v_exp_f32 v3, v3
    v_exp_f32 v4, v4
    v_exp_f32 v5, v5
    v_exp_f32 v6, v6
    v_exp_f32 v7, v7
    v_exp_f32 v8, v8
    v_exp_f32 v9, v9
    v_exp_f32 v10, v10
    v_exp_f32 v11, v11
    v_exp_f32 v12, v12
    v_exp_f32 v13, v13
    v_exp_f32 v14, v14
    v_exp_f32 v15, v15
    v_exp_f32 v16, v16
    v_exp_f32 v17, v17
    v_exp_f32 v18, v18
    v_exp_f32 v19, v19
    v_exp_f32 v20, v20
    v_exp_f32 v21, v21
    v_exp_f32 v22, v22
    v_exp_f32 v23, v23
    v_exp_f32 v24, v24
    v_exp_f32 v25, v25
    v_exp_f32 v26, v26
    v_exp_f32 v27, v27
    v_exp_f32 v28, v28
    v_exp_f32 v29, v29
    v_exp_f32 v30, v30
    v_exp_f32 v31, v31
    v_cvt_pk_bf16_f32 v40, v0, v1
    v_cvt_pk_bf16_f32 v41, v2, v3
    v_cvt_pk_bf16_f32 v42, v4, v5
    v_cvt_pk_bf16_f32 v43, v6, v7
    v_cvt_pk_bf16_f32 v44, v8, v9
    v_cvt_pk_bf16_f32 v45, v10, v11
    v_cvt_pk_bf16_f32 v46, v12, v13
    v_cvt_pk_bf16_f32 v47, v14, v15
    v_cvt_pk_bf16_f32 v48, v16, v17
    v_cvt_pk_bf16_f32 v49, v18, v19
    v_cvt_pk_bf16_f32 v50, v20, v21
    v_cvt_pk_bf16_f32 v51, v22, v23
    v_cvt_pk_bf16_f32 v52, v24, v25
    v_cvt_pk_bf16_f32 v53, v26, v27
    v_cvt_pk_bf16_f32 v54, v28, v29
    v_cvt_pk_bf16_f32 v55, v30, v31
    v_mfma_f32_16x16x32_bf16 v[4:7], v[158:161], v[40:43], 0
    v_mfma_f32_16x16x32_bf16 v[0:3], v[148:151], v[40:43], 0
    v_mfma_f32_16x16x32_bf16 v[12:15], v[160:163], v[44:47], 0
    v_mfma_f32_16x16x32_bf16 v[8:11], v[150:153], v[44:47], 0
    v_mfma_f32_16x16x32_bf16 v[20:23], v[162:165], v[48:51], 0
    v_mfma_f32_16x16x32_bf16 v[16:19], v[152:155], v[48:51], 0
    v_mfma_f32_16x16x32_bf16 v[28:31], v[164:167], v[52:55], 0
    v_mfma_f32_16x16x32_bf16 v[24:27], v[154:157], v[52:55], 0
    s_nop 0
    v_mov_b32 v56, v4
    v_mov_b32 v57, v4
    v_mov_b32 v58, v12
    v_mov_b32 v59, v12
    v_mov_b32 v60, v20
    v_mov_b32 v61, v20
    v_mov_b32 v62, v28
    v_mov_b32 v63, v28
    v_permlane32_swap_b32 v56, v57
    v_permlane32_swap_b32 v58, v59
    v_permlane32_swap_b32 v60, v61
    v_permlane32_swap_b32 v62, v63
    v_mov_b32 v56, v57
    v_mov_b32 v58, v59
    v_mov_b32 v60, v61
    v_mov_b32 v62, v63
    v_permlane16_swap_b32 v56, v57
    v_permlane16_swap_b32 v58, v59
    v_permlane16_swap_b32 v60, v61
    v_permlane16_swap_b32 v62, v63
    v_rcp_f32 v57, v57
    v_rcp_f32 v59, v59
    v_rcp_f32 v61, v61
    v_rcp_f32 v63, v63
    v_mul_f32 v0, v0, v57
    v_mul_f32 v1, v1, v57
    v_mul_f32 v2, v2, v57
    v_mul_f32 v3, v3, v57
    v_mul_f32 v4, v4, v57
    v_mul_f32 v5, v5, v57
    v_mul_f32 v6, v6, v57
    v_mul_f32 v7, v7, v57
    v_mul_f32 v8, v8, v59
    v_mul_f32 v9, v9, v59
    v_mul_f32 v10, v10, v59
    v_mul_f32 v11, v11, v59
    v_mul_f32 v12, v12, v59
    v_mul_f32 v13, v13, v59
    v_mul_f32 v14, v14, v59
    v_mul_f32 v15, v15, v59
    v_mul_f32 v16, v16, v61
    v_mul_f32 v17, v17, v61
    v_mul_f32 v18, v18, v61
    v_mul_f32 v19, v19, v61
    v_mul_f32 v20, v20, v61
    v_mul_f32 v21, v21, v61
    v_mul_f32 v22, v22, v61
    v_mul_f32 v23, v23, v61
    v_mul_f32 v24, v24, v63
    v_mul_f32 v25, v25, v63
    v_mul_f32 v26, v26, v63
    v_mul_f32 v27, v27, v63
    v_mul_f32 v28, v28, v63
    v_mul_f32 v29, v29, v63
    v_mul_f32 v30, v30, v63
    v_mul_f32 v31, v31, v63
    v_cvt_pk_bf16_f32 v100, v0, v1
    v_cvt_pk_bf16_f32 v101, v2, v3
    v_cvt_pk_bf16_f32 v102, v4, v5
    v_cvt_pk_bf16_f32 v103, v6, v7
    v_cvt_pk_bf16_f32 v104, v8, v9
    v_cvt_pk_bf16_f32 v105, v10, v11
    v_cvt_pk_bf16_f32 v106, v12, v13
    v_cvt_pk_bf16_f32 v107, v14, v15
    v_cvt_pk_bf16_f32 v108, v16, v17
    v_cvt_pk_bf16_f32 v109, v18, v19
    v_cvt_pk_bf16_f32 v110, v20, v21
    v_cvt_pk_bf16_f32 v111, v22, v23
    v_cvt_pk_bf16_f32 v112, v24, v25
    v_cvt_pk_bf16_f32 v113, v26, v27
    v_cvt_pk_bf16_f32 v114, v28, v29
    v_cvt_pk_bf16_f32 v115, v30, v31
    v_bfi_b32 v103, v250, v103, v253
    v_bfi_b32 v107, v250, v107, v253
    v_bfi_b32 v111, v250, v111, v253
    v_bfi_b32 v115, v250, v115, v253
L_noB1:
    ds_read_b64_tr_b16 v[128:129], v242 offset:0
    ds_read_b64_tr_b16 v[130:131], v246 offset:0
    ds_read_b64_tr_b16 v[132:133], v243 offset:0
    ds_read_b64_tr_b16 v[134:135], v247 offset:0
    ds_read_b64_tr_b16 v[136:137], v244 offset:0
    ds_read_b64_tr_b16 v[138:139], v248 offset:0
    ds_read_b64_tr_b16 v[140:141], v245 offset:0
    ds_read_b64_tr_b16 v[142:143], v249 offset:0
    ds_read_b64_tr_b16 v[144:145], v244 offset:3584
    ds_read_b64_tr_b16 v[146:147], v248 offset:3584
    ds_read_b64_tr_b16 v[148:149], v245 offset:3584
    ds_read_b64_tr_b16 v[150:151], v249 offset:3584
    ds_read_b64_tr_b16 v[152:153], v242 offset:3584
    ds_read_b64_tr_b16 v[154:155], v246 offset:3584
    ds_read_b64_tr_b16 v[156:157], v243 offset:3584
    ds_read_b64_tr_b16 v[158:159], v247 offset:3584
    ds_read_b64_tr_b16 v[160:161], v242 offset:7168
    ds_read_b64_tr_b16 v[162:163], v246 offset:7168
    ds_read_b64_tr_b16 v[164:165], v243 offset:7168
    ds_read_b64_tr_b16 v[166:167], v247 offset:7168
    ds_read_b64_tr_b16 v[168:169], v244 offset:7168
    ds_read_b64_tr_b16 v[170:171], v248 offset:7168
    ds_read_b64_tr_b16 v[172:173], v245 offset:7168
    ds_read_b64_tr_b16 v[174:175], v249 offset:7168
    ds_read_b64_tr_b16 v[176:177], v244 offset:10752
    ds_read_b64_tr_b16 v[178:179], v248 offset:10752
    ds_read_b64_tr_b16 v[180:181], v245 offset:10752
    ds_read_b64_tr_b16 v[182:183], v249 offset:10752
    ds_read_b64_tr_b16 v[184:185], v242 offset:10752
    ds_read_b64_tr_b16 v[186:187], v246 offset:10752
    ds_read_b64_tr_b16 v[188:189], v243 offset:10752
    ds_read_b64_tr_b16 v[190:191], v247 offset:10752
    s_mov_b32 s14, 40000
    v_lshlrev_b32 v8, 2, v241
    v_sub_u32 v8, v8, v240
    s_bitcmp1_b32 s4, 0
    s_cselect_b64 s[34:35], -1, 0
    v_add_u32 v9, 0, v8
    v_cmp_lt_i32 vcc, 0, v9
    s_nop 1
    v_cndmask_b32 v10, v237, 0, vcc
    v_cndmask_b32 v11, 0, v237, vcc
    v_cndmask_b32 v0, v10, v237, s[34:35]
    v_cndmask_b32 v4, 0, v10, s[34:35]
    v_cndmask_b32 v64, v11, 0, s[34:35]
    v_cndmask_b32 v68, v237, v11, s[34:35]
    v_add_u32 v9, 1, v8
    v_cmp_lt_i32 vcc, 0, v9
    s_nop 1
    v_cndmask_b32 v10, v237, 0, vcc
    v_cndmask_b32 v11, 0, v237, vcc
    v_cndmask_b32 v1, v10, v237, s[34:35]
    v_cndmask_b32 v5, 0, v10, s[34:35]
    v_cndmask_b32 v65, v11, 0, s[34:35]
    v_cndmask_b32 v69, v237, v11, s[34:35]
    v_add_u32 v9, 2, v8
    v_cmp_lt_i32 vcc, 0, v9
    s_nop 1
    v_cndmask_b32 v10, v237, 0, vcc
    v_cndmask_b32 v11, 0, v237, vcc
    v_cndmask_b32 v2, v10, v237, s[34:35]
    v_cndmask_b32 v6, 0, v10, s[34:35]
    v_cndmask_b32 v66, v11, 0, s[34:35]
    v_cndmask_b32 v70, v237, v11, s[34:35]
    v_add_u32 v9, 3, v8
    v_cmp_lt_i32 vcc, 0, v9
    s_nop 1
    v_cndmask_b32 v10, v237, 0, vcc
    v_cndmask_b32 v11, 0, v237, vcc
    v_cndmask_b32 v3, v10, v237, s[34:35]
    v_cndmask_b32 v7, 0, v10, s[34:35]
    v_cndmask_b32 v67, v11, 0, s[34:35]
    v_cndmask_b32 v71, v237, v11, s[34:35]
    v_add_u32 v242, 57344, v242
    v_add_u32 v243, 57344, v243
    v_add_u32 v244, 57344, v244
    v_add_u32 v245, 57344, v245
    v_add_u32 v246, 57344, v246
    v_add_u32 v247, 57344, v247
    v_add_u32 v248, 57344, v248
    v_add_u32 v249, 57344, v249
    s_waitcnt lgkmcnt(0)
    v_and_b32 v130, v250, v130
    v_and_b32 v131, v250, v131
    v_and_b32 v134, v250, v134
    v_and_b32 v135, v250, v135
    v_and_b32 v138, v250, v138
    v_and_b32 v139, v250, v139
    v_and_b32 v142, v250, v142
    v_and_b32 v143, v250, v143
    v_and_b32 v146, v250, v146
    v_and_b32 v147, v250, v147
    v_and_b32 v150, v250, v150
    v_and_b32 v151, v250, v151
    v_and_b32 v154, v250, v154
    v_and_b32 v155, v250, v155
    v_and_b32 v158, v250, v158
    v_and_b32 v159, v250, v159
    v_and_b32 v162, v250, v162
    v_and_b32 v163, v250, v163
    v_and_b32 v166, v250, v166
    v_and_b32 v167, v250, v167
    v_and_b32 v170, v250, v170
    v_and_b32 v171, v250, v171
    v_and_b32 v174, v250, v174
    v_and_b32 v175, v250, v175
    v_and_b32 v178, v250, v178
    v_and_b32 v179, v250, v179
    v_and_b32 v182, v250, v182
    v_and_b32 v183, v250, v183
    v_and_b32 v186, v250, v186
    v_and_b32 v187, v250, v187
    v_and_b32 v190, v250, v190
    v_and_b32 v191, v250, v191
    s_cmp_ge_u32 s9, 2
    s_cbranch_scc1 L_nofix
    s_waitcnt vmcnt(4)
    v_not_b32 v9, v228
    v_not_b32 v10, v229
    v_and_b32 v9, 0xff7f, v9
    v_and_b32 v10, 0xff7f, v10
    v_and_b32 v72, v228, v72
    v_and_b32 v73, v228, v73
    v_and_b32 v74, v229, v74
    v_and_b32 v75, v229, v75
    s_cmp_eq_u32 s16, 1073741824
    s_cbranch_scc0 L_fx0
    v_or_b32 v72, v9, v72
    v_or_b32 v74, v10, v74
L_fx0:
    v_and_b32 v76, v228, v76
    v_and_b32 v77, v228, v77
    v_and_b32 v78, v229, v78
    v_and_b32 v79, v229, v79
    s_cmp_eq_u32 s17, 1073741824
    s_cbranch_scc0 L_fx1
    v_or_b32 v76, v9, v76
    v_or_b32 v78, v10, v78
L_fx1:
    v_and_b32 v80, v228, v80
    v_and_b32 v81, v228, v81
    v_and_b32 v82, v229, v82
    v_and_b32 v83, v229, v83
    s_cmp_eq_u32 s18, 1073741824
    s_cbranch_scc0 L_fx2
    v_or_b32 v80, v9, v80
    v_or_b32 v82, v10, v82
L_fx2:
L_nofix:
    s_waitcnt vmcnt(6)
    ds_write_b128 v238, v[72:75] offset:0
    s_waitcnt vmcnt(5)
    ds_write_b128 v238, v[76:79] offset:1024
    s_waitcnt vmcnt(4)
    ds_write_b128 v238, v[80:83] offset:2048
    s_waitcnt vmcnt(2)
    v_or_b32 v84, v230, v84
    v_or_b32 v85, v230, v85
    v_or_b32 v86, v230, v86
    v_or_b32 v87, v230, v87
    ds_write_b128 v238, v[84:87] offset:24576
    s_waitcnt vmcnt(1)
    v_or_b32 v88, v231, v88
    v_or_b32 v89, v231, v89
    v_or_b32 v90, v231, v90
    v_or_b32 v91, v231, v91
    ds_write_b128 v238, v[88:91] offset:25600
    s_waitcnt vmcnt(0)
    v_or_b32 v92, v230, v92
    v_or_b32 v93, v230, v93
    v_or_b32 v94, v230, v94
    v_or_b32 v95, v230, v95
    ds_write_b128 v238, v[92:95] offset:26624
    s_lshr_b32 s3, s4, 2
    s_cmp_gt_u32 s5, s3
    s_cbranch_scc0 L_noB2
    buffer_store_dwordx4 v[100:103], v233, s[52:55], s36 offen sc1
    s_add_u32 s36, s36, 16384
    buffer_store_dwordx4 v[104:107], v233, s[52:55], s36 offen sc1
    s_add_u32 s36, s36, 16384
    buffer_store_dwordx4 v[108:111], v233, s[52:55], s36 offen sc1
    s_add_u32 s36, s36, 16384
    buffer_store_dwordx4 v[112:115], v233, s[52:55], s36 offen sc1
L_noB2:
    v_and_b32 v124, v228, v124
    v_and_b32 v125, v228, v125
    v_and_b32 v126, v229, v126
    v_and_b32 v127, v229, v127
    s_cmp_ge_u32 s9, 2
    s_cbranch_scc1 L_nofixq
    v_not_b32 v9, v228
    v_not_b32 v10, v229
    v_and_b32 v9, 0x3f80, v9
    v_or_b32 v124, v9, v124
    v_and_b32 v10, 0x3f80, v10
    v_or_b32 v126, v10, v126
L_nofixq:
    s_waitcnt lgkmcnt(0)
    s_barrier
    ds_read_b128 v[72:75], v239 offset:0
    ds_read_b128 v[76:79], v239 offset:1024
    ds_read_b128 v[80:83], v239 offset:2048
    ds_read_b128 v[84:87], v239 offset:3072
    ds_read_b128 v[88:91], v239 offset:4096
    ds_read_b128 v[92:95], v239 offset:5120
    s_waitcnt lgkmcnt(5)
    v_mfma_f32_16x16x32_bf16 v[0:3], v[72:75], v[124:127], v[0:3]
    ds_read_b128 v[72:75], v239 offset:6144
    s_waitcnt lgkmcnt(5)
    v_mfma_f32_16x16x32_bf16 v[4:7], v[76:79], v[124:127], v[4:7]
    ds_read_b128 v[76:79], v239 offset:7168
    s_waitcnt lgkmcnt(5)
    v_mfma_f32_16x16x32_bf16 v[8:11], v[80:83], v[124:127], 0
    ds_read_b128 v[80:83], v239 offset:8192
    s_waitcnt lgkmcnt(5)
    v_mfma_f32_16x16x32_bf16 v[12:15], v[84:87], v[124:127], 0
    ds_read_b128 v[84:87], v239 offset:9216
    s_waitcnt lgkmcnt(5)
    v_mfma_f32_16x16x32_bf16 v[16:19], v[88:91], v[124:127], 0
    v_max_f32 v120, v0, v1
    v_max_f32 v121, v2, v3
    ds_read_b128 v[88:91], v239 offset:10240
    s_waitcnt lgkmcnt(5)
    v_mfma_f32_16x16x32_bf16 v[20:23], v[92:95], v[124:127], 0
    v_max3_f32 v120, v120, v4, v5
    v_max3_f32 v121, v121, v6, v7
    ds_read_b128 v[92:95], v239 offset:11264
    s_waitcnt lgkmcnt(5)
    v_mfma_f32_16x16x32_bf16 v[24:27], v[72:75], v[124:127], 0
    v_max3_f32 v120, v120, v8, v9
    v_max3_f32 v121, v121, v10, v11
    ds_read_b128 v[72:75], v239 offset:12288
    s_waitcnt lgkmcnt(5)
    v_mfma_f32_16x16x32_bf16 v[28:31], v[76:79], v[124:127], 0
    v_max3_f32 v120, v120, v12, v13
    v_max3_f32 v121, v121, v14, v15
    ds_read_b128 v[76:79], v239 offset:13312
    s_waitcnt lgkmcnt(5)
    v_mfma_f32_16x16x32_bf16 v[32:35], v[80:83], v[124:127], 0
    v_max3_f32 v120, v120, v16, v17
    v_max3_f32 v121, v121, v18, v19
    ds_read_b128 v[80:83], v239 offset:14336
    s_waitcnt lgkmcnt(5)
    v_mfma_f32_16x16x32_bf16 v[36:39], v[84:87], v[124:127], 0
    v_max3_f32 v120, v120, v20, v21
    v_max3_f32 v121, v121, v22, v23
    ds_read_b128 v[84:87], v239 offset:15360
    s_waitcnt lgkmcnt(5)
    v_mfma_f32_16x16x32_bf16 v[40:43], v[88:91], v[124:127], 0
    v_max3_f32 v120, v120, v24, v25
    v_max3_f32 v121, v121, v26, v27
    ds_read_b128 v[88:91], v239 offset:16384
    s_waitcnt lgkmcnt(5)
    v_mfma_f32_16x16x32_bf16 v[44:47], v[92:95], v[124:127], 0
    v_max3_f32 v120, v120, v28, v29
    v_max3_f32 v121, v121, v30, v31
    ds_read_b128 v[92:95], v239 offset:17408
    s_waitcnt lgkmcnt(5)
    v_mfma_f32_16x16x32_bf16 v[48:51], v[72:75], v[124:127], 0
    v_max3_f32 v120, v120, v32, v33
    v_max3_f32 v121, v121, v34, v35
    s_waitcnt lgkmcnt(4)
    v_mfma_f32_16x16x32_bf16 v[52:55], v[76:79], v[124:127], 0
    v_max3_f32 v120, v120, v36, v37
    v_max3_f32 v121, v121, v38, v39
    s_waitcnt lgkmcnt(3)
    v_mfma_f32_16x16x32_bf16 v[56:59], v[80:83], v[124:127], 0
    v_max3_f32 v120, v120, v40, v41
    v_max3_f32 v121, v121, v42, v43
    s_waitcnt lgkmcnt(2)
    v_mfma_f32_16x16x32_bf16 v[60:63], v[84:87], v[124:127], 0
    v_max3_f32 v120, v120, v44, v45
    v_max3_f32 v121, v121, v46, v47
    s_waitcnt lgkmcnt(1)
    v_mfma_f32_16x16x32_bf16 v[64:67], v[88:91], v[124:127], v[64:67]
    v_max3_f32 v120, v120, v48, v49
    v_max3_f32 v121, v121, v50, v51
    s_waitcnt lgkmcnt(0)
    v_mfma_f32_16x16x32_bf16 v[68:71], v[92:95], v[124:127], v[68:71]
    v_max3_f32 v120, v120, v52, v53
    v_max3_f32 v121, v121, v54, v55
    ds_read_b128 v[96:99], v239 offset:24576
    ds_read_b128 v[100:103], v239 offset:25600
    ds_read_b128 v[104:107], v239 offset:26624
    ds_read_b128 v[108:111], v239 offset:27648
    ds_read_b128 v[112:115], v239 offset:28672
    ds_read_b128 v[116:119], v239 offset:29696
    v_max3_f32 v120, v120, v56, v57
    v_max3_f32 v121, v121, v58, v59
    v_max3_f32 v120, v120, v60, v61
    v_max3_f32 v121, v121, v62, v63
    v_max3_f32 v120, v120, v64, v65
    v_max3_f32 v121, v121, v66, v67
    v_max3_f32 v120, v120, v68, v69
    v_max3_f32 v121, v121, v70, v71
    v_max_f32 v120, v120, v121
    v_mov_b32 v121, v120
    s_nop 1
    v_permlane32_swap_b32 v120, v121
    v_max_f32 v120, v120, v121
    v_mov_b32 v121, v120
    s_nop 1
    v_permlane16_swap_b32 v120, v121
    v_max_f32 v120, v120, v121
    v_mul_f32 v120, v252, v120
    s_mov_b32 s27, 0
    v_fma_f32 v0, v0, v252, -v120
    v_fma_f32 v1, v1, v252, -v120
    v_fma_f32 v2, v2, v252, -v120
    v_fma_f32 v3, v3, v252, -v120
    v_fma_f32 v4, v4, v252, -v120
    v_fma_f32 v5, v5, v252, -v120
    v_fma_f32 v6, v6, v252, -v120
    v_fma_f32 v7, v7, v252, -v120
    v_exp_f32 v0, v0
    v_exp_f32 v1, v1
    v_exp_f32 v2, v2
    v_exp_f32 v3, v3
    v_exp_f32 v4, v4
    v_exp_f32 v5, v5
    v_exp_f32 v6, v6
    v_exp_f32 v7, v7
    v_cvt_pk_bf16_f32 v0, v0, v1
    v_cvt_pk_bf16_f32 v1, v2, v3
    v_cvt_pk_bf16_f32 v2, v4, v5
    v_cvt_pk_bf16_f32 v3, v6, v7
    s_waitcnt lgkmcnt(4)
    s_nop 0
    v_mfma_f32_16x16x32_bf16 v[224:227], v[96:99], v[0:3], 0
    v_mfma_f32_16x16x32_bf16 v[228:231], v[100:103], v[0:3], 0
    ds_read_b128 v[96:99], v239 offset:30720
    ds_read_b128 v[100:103], v239 offset:31744
    v_fma_f32 v8, v8, v252, -v120
    v_fma_f32 v9, v9, v252, -v120
    v_fma_f32 v10, v10, v252, -v120
    v_fma_f32 v11, v11, v252, -v120
    v_fma_f32 v12, v12, v252, -v120
    v_fma_f32 v13, v13, v252, -v120
    v_fma_f32 v14, v14, v252, -v120
    v_fma_f32 v15, v15, v252, -v120
    v_exp_f32 v8, v8
    v_exp_f32 v9, v9
    v_exp_f32 v10, v10
    v_exp_f32 v11, v11
    v_exp_f32 v12, v12
    v_exp_f32 v13, v13
    v_exp_f32 v14, v14
    v_exp_f32 v15, v15
    v_cvt_pk_bf16_f32 v8, v8, v9
    v_cvt_pk_bf16_f32 v9, v10, v11
    v_cvt_pk_bf16_f32 v10, v12, v13
    v_cvt_pk_bf16_f32 v11, v14, v15
    s_waitcnt lgkmcnt(4)
    s_nop 0
    v_mfma_f32_16x16x32_bf16 v[224:227], v[104:107], v[8:11], v[224:227]
    v_mfma_f32_16x16x32_bf16 v[228:231], v[108:111], v[8:11], v[228:231]
    ds_read_b128 v[104:107], v239 offset:32768
    ds_read_b128 v[108:111], v239 offset:33792
    v_fma_f32 v16, v16, v252, -v120
    v_fma_f32 v17, v17, v252, -v120
    v_fma_f32 v18, v18, v252, -v120
    v_fma_f32 v19, v19, v252, -v120
    v_fma_f32 v20, v20, v252, -v120
    v_fma_f32 v21, v21, v252, -v120
    v_fma_f32 v22, v22, v252, -v120
    v_fma_f32 v23, v23, v252, -v120
    v_exp_f32 v16, v16
    v_exp_f32 v17, v17
    v_exp_f32 v18, v18
    v_exp_f32 v19, v19
    v_exp_f32 v20, v20
    v_exp_f32 v21, v21
    v_exp_f32 v22, v22
    v_exp_f32 v23, v23
    v_cvt_pk_bf16_f32 v16, v16, v17
    v_cvt_pk_bf16_f32 v17, v18, v19
    v_cvt_pk_bf16_f32 v18, v20, v21
    v_cvt_pk_bf16_f32 v19, v22, v23
    s_waitcnt lgkmcnt(4)
    s_nop 0
    v_mfma_f32_16x16x32_bf16 v[224:227], v[112:115], v[16:19], v[224:227]
    v_mfma_f32_16x16x32_bf16 v[228:231], v[116:119], v[16:19], v[228:231]
    ds_read_b128 v[112:115], v239 offset:34816
    ds_read_b128 v[116:119], v239 offset:35840
    v_fma_f32 v24, v24, v252, -v120
    v_fma_f32 v25, v25, v252, -v120
    v_fma_f32 v26, v26, v252, -v120
    v_fma_f32 v27, v27, v252, -v120
    v_fma_f32 v28, v28, v252, -v120
    v_fma_f32 v29, v29, v252, -v120
    v_fma_f32 v30, v30, v252, -v120
    v_fma_f32 v31, v31, v252, -v120
    v_exp_f32 v24, v24
    v_exp_f32 v25, v25
    v_exp_f32 v26, v26
    v_exp_f32 v27, v27
    v_exp_f32 v28, v28
    v_exp_f32 v29, v29
    v_exp_f32 v30, v30
    v_exp_f32 v31, v31
    v_cvt_pk_bf16_f32 v24, v24, v25
    v_cvt_pk_bf16_f32 v25, v26, v27
    v_cvt_pk_bf16_f32 v26, v28, v29
    v_cvt_pk_bf16_f32 v27, v30, v31
    s_waitcnt lgkmcnt(4)
    s_nop 0
    v_mfma_f32_16x16x32_bf16 v[224:227], v[96:99], v[24:27], v[224:227]
    v_mfma_f32_16x16x32_bf16 v[228:231], v[100:103], v[24:27], v[228:231]
    ds_read_b128 v[96:99], v239 offset:36864
    ds_read_b128 v[100:103], v239 offset:37888
    v_fma_f32 v32, v32, v252, -v120
    v_fma_f32 v33, v33, v252, -v120
    v_fma_f32 v34, v34, v252, -v120
    v_fma_f32 v35, v35, v252, -v120
    v_fma_f32 v36, v36, v252, -v120
    v_fma_f32 v37, v37, v252, -v120
    v_fma_f32 v38, v38, v252, -v120
    v_fma_f32 v39, v39, v252, -v120
    buffer_load_dwordx4 v[192:195], v233, s[52:55], s96 offen offset:0 sc1
    buffer_load_dwordx4 v[196:199], v233, s[52:55], s97 offen offset:0 sc1
    v_exp_f32 v32, v32
    v_exp_f32 v33, v33
    v_exp_f32 v34, v34
    v_exp_f32 v35, v35
    v_exp_f32 v36, v36
    v_exp_f32 v37, v37
    v_exp_f32 v38, v38
    v_exp_f32 v39, v39
    v_cvt_pk_bf16_f32 v32, v32, v33
    v_cvt_pk_bf16_f32 v33, v34, v35
    v_cvt_pk_bf16_f32 v34, v36, v37
    v_cvt_pk_bf16_f32 v35, v38, v39
    s_waitcnt lgkmcnt(4)
    s_nop 0
    v_mfma_f32_16x16x32_bf16 v[224:227], v[104:107], v[32:35], v[224:227]
    v_mfma_f32_16x16x32_bf16 v[228:231], v[108:111], v[32:35], v[228:231]
    ds_read_b128 v[104:107], v239 offset:38912
    ds_read_b128 v[108:111], v239 offset:39936
    v_fma_f32 v40, v40, v252, -v120
    v_fma_f32 v41, v41, v252, -v120
    v_fma_f32 v42, v42, v252, -v120
    v_fma_f32 v43, v43, v252, -v120
    v_fma_f32 v44, v44, v252, -v120
    v_fma_f32 v45, v45, v252, -v120
    v_fma_f32 v46, v46, v252, -v120
    v_fma_f32 v47, v47, v252, -v120
    buffer_load_dwordx4 v[200:203], v233, s[52:55], s96 offen offset:1024 sc1
    buffer_load_dwordx4 v[204:207], v233, s[52:55], s97 offen offset:1024 sc1
    v_exp_f32 v40, v40
    v_exp_f32 v41, v41
    v_exp_f32 v42, v42
    v_exp_f32 v43, v43
    v_exp_f32 v44, v44
    v_exp_f32 v45, v45
    v_exp_f32 v46, v46
    v_exp_f32 v47, v47
    v_cvt_pk_bf16_f32 v40, v40, v41
    v_cvt_pk_bf16_f32 v41, v42, v43
    v_cvt_pk_bf16_f32 v42, v44, v45
    v_cvt_pk_bf16_f32 v43, v46, v47
    s_waitcnt lgkmcnt(4)
    s_nop 0
    v_mfma_f32_16x16x32_bf16 v[224:227], v[112:115], v[40:43], v[224:227]
    v_mfma_f32_16x16x32_bf16 v[228:231], v[116:119], v[40:43], v[228:231]
    ds_read_b128 v[112:115], v239 offset:40960
    ds_read_b128 v[116:119], v239 offset:41984
    v_fma_f32 v48, v48, v252, -v120
    v_fma_f32 v49, v49, v252, -v120
    v_fma_f32 v50, v50, v252, -v120
    v_fma_f32 v51, v51, v252, -v120
    v_fma_f32 v52, v52, v252, -v120
    v_fma_f32 v53, v53, v252, -v120
    v_fma_f32 v54, v54, v252, -v120
    v_fma_f32 v55, v55, v252, -v120
    buffer_load_dwordx4 v[208:211], v233, s[52:55], s96 offen offset:2048 sc1
    buffer_load_dwordx4 v[212:215], v233, s[52:55], s97 offen offset:2048 sc1
    v_exp_f32 v48, v48
    v_exp_f32 v49, v49
    v_exp_f32 v50, v50
    v_exp_f32 v51, v51
    v_exp_f32 v52, v52
    v_exp_f32 v53, v53
    v_exp_f32 v54, v54
    v_exp_f32 v55, v55
    v_cvt_pk_bf16_f32 v48, v48, v49
    v_cvt_pk_bf16_f32 v49, v50, v51
    v_cvt_pk_bf16_f32 v50, v52, v53
    v_cvt_pk_bf16_f32 v51, v54, v55
    s_waitcnt lgkmcnt(4)
    s_nop 0
    v_mfma_f32_16x16x32_bf16 v[224:227], v[96:99], v[48:51], v[224:227]
    v_mfma_f32_16x16x32_bf16 v[228:231], v[100:103], v[48:51], v[228:231]
    v_fma_f32 v56, v56, v252, -v120
    v_fma_f32 v57, v57, v252, -v120
    v_fma_f32 v58, v58, v252, -v120
    v_fma_f32 v59, v59, v252, -v120
    v_fma_f32 v60, v60, v252, -v120
    v_fma_f32 v61, v61, v252, -v120
    v_fma_f32 v62, v62, v252, -v120
    v_fma_f32 v63, v63, v252, -v120
    buffer_load_dwordx4 v[216:219], v233, s[52:55], s96 offen offset:3072 sc1
    buffer_load_dwordx4 v[220:223], v233, s[52:55], s97 offen offset:3072 sc1
    v_exp_f32 v56, v56
    v_exp_f32 v57, v57
    v_exp_f32 v58, v58
    v_exp_f32 v59, v59
    v_exp_f32 v60, v60
    v_exp_f32 v61, v61
    v_exp_f32 v62, v62
    v_exp_f32 v63, v63
    v_cvt_pk_bf16_f32 v56, v56, v57
    v_cvt_pk_bf16_f32 v57, v58, v59
    v_cvt_pk_bf16_f32 v58, v60, v61
    v_cvt_pk_bf16_f32 v59, v62, v63
    s_waitcnt lgkmcnt(2)
    s_nop 0
    v_mfma_f32_16x16x32_bf16 v[224:227], v[104:107], v[56:59], v[224:227]
    v_mfma_f32_16x16x32_bf16 v[228:231], v[108:111], v[56:59], v[228:231]
    v_fma_f32 v64, v64, v252, -v120
    v_fma_f32 v65, v65, v252, -v120
    v_fma_f32 v66, v66, v252, -v120
    v_fma_f32 v67, v67, v252, -v120
    v_fma_f32 v68, v68, v252, -v120
    v_fma_f32 v69, v69, v252, -v120
    v_fma_f32 v70, v70, v252, -v120
    v_fma_f32 v71, v71, v252, -v120
    v_exp_f32 v64, v64
    v_exp_f32 v65, v65
    v_exp_f32 v66, v66
    v_exp_f32 v67, v67
    v_exp_f32 v68, v68
    v_exp_f32 v69, v69
    v_exp_f32 v70, v70
    v_exp_f32 v71, v71
    v_cvt_pk_bf16_f32 v64, v64, v65
    v_cvt_pk_bf16_f32 v65, v66, v67
    v_cvt_pk_bf16_f32 v66, v68, v69
    v_cvt_pk_bf16_f32 v67, v70, v71
    s_waitcnt lgkmcnt(0)
    s_nop 0
    v_mfma_f32_16x16x32_bf16 v[224:227], v[112:115], v[64:67], v[224:227]
    v_mfma_f32_16x16x32_bf16 v[228:231], v[116:119], v[64:67], v[228:231]
    ds_read_b64_tr_b16 v[0:1], v242 offset:0
    ds_read_b64_tr_b16 v[2:3], v246 offset:0
    ds_read_b64_tr_b16 v[4:5], v243 offset:0
    ds_read_b64_tr_b16 v[6:7], v247 offset:0
    ds_read_b64_tr_b16 v[8:9], v244 offset:0
    ds_read_b64_tr_b16 v[10:11], v248 offset:0
    ds_read_b64_tr_b16 v[12:13], v245 offset:0
    ds_read_b64_tr_b16 v[14:15], v249 offset:0
    ds_read_b64_tr_b16 v[16:17], v244 offset:3584
    ds_read_b64_tr_b16 v[18:19], v248 offset:3584
    ds_read_b64_tr_b16 v[20:21], v245 offset:3584
    ds_read_b64_tr_b16 v[22:23], v249 offset:3584
    ds_read_b64_tr_b16 v[24:25], v242 offset:3584
    ds_read_b64_tr_b16 v[26:27], v246 offset:3584
    ds_read_b64_tr_b16 v[28:29], v243 offset:3584
    ds_read_b64_tr_b16 v[30:31], v247 offset:3584
    ds_read_b64_tr_b16 v[32:33], v242 offset:7168
    ds_read_b64_tr_b16 v[34:35], v246 offset:7168
    ds_read_b64_tr_b16 v[36:37], v243 offset:7168
    ds_read_b64_tr_b16 v[38:39], v247 offset:7168
    ds_read_b64_tr_b16 v[40:41], v244 offset:7168
    ds_read_b64_tr_b16 v[42:43], v248 offset:7168
    ds_read_b64_tr_b16 v[44:45], v245 offset:7168
    ds_read_b64_tr_b16 v[46:47], v249 offset:7168
    ds_read_b64_tr_b16 v[48:49], v244 offset:10752
    ds_read_b64_tr_b16 v[50:51], v248 offset:10752
    ds_read_b64_tr_b16 v[52:53], v245 offset:10752
    ds_read_b64_tr_b16 v[54:55], v249 offset:10752
    ds_read_b64_tr_b16 v[56:57], v242 offset:10752
    ds_read_b64_tr_b16 v[58:59], v246 offset:10752
    ds_read_b64_tr_b16 v[60:61], v243 offset:10752
    ds_read_b64_tr_b16 v[62:63], v247 offset:10752
    v_mov_b32 v232, v228
    v_mov_b32 v234, v228
    s_nop 1
    v_permlane32_swap_b32 v232, v234
    v_mov_b32 v232, v234
    s_nop 1
    v_permlane16_swap_b32 v232, v234
    v_rcp_f32 v234, v234
    s_nop 0
    v_mul_f32 v224, v224, v234
    v_mul_f32 v225, v225, v234
    v_mul_f32 v226, v226, v234
    v_mul_f32 v227, v227, v234
    v_mul_f32 v228, v228, v234
    v_mul_f32 v229, v229, v234
    v_mul_f32 v230, v230, v234
    v_mul_f32 v231, v231, v234
    v_cvt_pk_bf16_f32 v236, v224, v225
    v_cvt_pk_bf16_f32 v237, v226, v227
    v_cvt_pk_bf16_f32 v238, v228, v229
    v_cvt_pk_bf16_f32 v239, v230, v231
    v_bfi_b32 v239, v250, v239, v253
    buffer_store_dwordx4 v[236:239], v233, s[52:55], s33 offen sc1
    s_cmp_eq_u32 s11, 7
    s_cbranch_scc1 L_fin
    s_lshl_b32 s3, s61, 14
    s_lshl_b32 s35, s60, 13
    s_add_u32 s35, s35, s3
    v_lshlrev_b32 v231, 8, v240
    v_add_u32 v231, s35, v231
    v_xor_b32 v232, v241, v240
    s_add_u32 s3, s61, 0
    s_and_b32 s3, s3, 3
    s_lshl_b32 s3, s3, 2
    v_xor_b32 v234, s3, v232
    v_lshl_add_u32 v224, v234, 4, v231
    s_add_u32 s3, s61, 1
    s_and_b32 s3, s3, 3
    s_lshl_b32 s3, s3, 2
    v_xor_b32 v234, s3, v232
    v_lshl_add_u32 v225, v234, 4, v231
    s_add_u32 s3, s61, 2
    s_and_b32 s3, s3, 3
    s_lshl_b32 s3, s3, 2
    v_xor_b32 v234, s3, v232
    v_lshl_add_u32 v226, v234, 4, v231
    s_add_u32 s3, s61, 3
    s_and_b32 s3, s3, 3
    s_lshl_b32 s3, s3, 2
    v_xor_b32 v234, s3, v232
    v_lshl_add_u32 v227, v234, 4, v231
    v_lshrrev_b32 v231, 3, v255
    s_lshl_b32 s3, s4, 3
    v_add_u32 v231, s3, v231
    v_and_b32 v232, 7, v255
    v_lshlrev_b32 v234, 1, v232
    v_and_b32 v235, 15, v231
    v_xor_b32 v234, v234, v235
    v_lshlrev_b32 v234, 4, v234
    v_lshl_add_u32 v228, v231, 8, v234
    v_xor_b32 v229, 16, v228
    s_lshl_b32 s3, s10, 6
    v_add_u32 v231, s3, v231
    v_mul_u32_u24 v231, 1792, v231
    v_lshl_add_u32 v231, v232, 4, v231
    s_lshl_b32 s3, s11, 7
    v_add_u32 v230, s3, v231
    s_cmp_lg_u32 s27, 0
    s_cbranch_scc1 L_skR0
    s_waitcnt vmcnt(8)
    v_cmp_ne_u32 vcc, v195, v253
    s_nop 3
    s_lshr_b32 s3, vcc_hi, 16
    s_cbranch_scc1 L_skR0
    v_mfma_f32_16x16x32_bf16 v[64:67], v[128:131], v[192:195], 0
    v_mfma_f32_16x16x32_bf16 v[68:71], v[132:135], v[192:195], 0
    v_mfma_f32_16x16x32_bf16 v[72:75], v[136:139], v[192:195], 0
    v_mfma_f32_16x16x32_bf16 v[76:79], v[140:143], v[192:195], 0
    s_add_u32 s27, s27, 1
L_skR0:
    s_cmp_lg_u32 s27, 1
    s_cbranch_scc1 L_skR1
    s_waitcnt vmcnt(7)
    v_cmp_ne_u32 vcc, v199, v253
    s_nop 3
    s_lshr_b32 s3, vcc_hi, 16
    s_cbranch_scc1 L_skR1
    v_mfma_f32_16x16x32_bf16 v[80:83], v[128:131], v[196:199], 0
    v_mfma_f32_16x16x32_bf16 v[84:87], v[132:135], v[196:199], 0
    v_mfma_f32_16x16x32_bf16 v[88:91], v[136:139], v[196:199], 0
    v_mfma_f32_16x16x32_bf16 v[92:95], v[140:143], v[196:199], 0
    s_add_u32 s27, s27, 1
L_skR1:
    s_cmp_lg_u32 s27, 2
    s_cbranch_scc1 L_skR2
    s_waitcnt vmcnt(6)
    v_cmp_ne_u32 vcc, v203, v253
    s_nop 3
    s_lshr_b32 s3, vcc_hi, 16
    s_cbranch_scc1 L_skR2
    v_mfma_f32_16x16x32_bf16 v[64:67], v[144:147], v[200:203], v[64:67]
    v_mfma_f32_16x16x32_bf16 v[68:71], v[148:151], v[200:203], v[68:71]
    v_mfma_f32_16x16x32_bf16 v[72:75], v[152:155], v[200:203], v[72:75]
    v_mfma_f32_16x16x32_bf16 v[76:79], v[156:159], v[200:203], v[76:79]
    s_add_u32 s27, s27, 1
L_skR2:
    s_cmp_lg_u32 s27, 3
    s_cbranch_scc1 L_skR3
    s_waitcnt vmcnt(5)
    v_cmp_ne_u32 vcc, v207, v253
    s_nop 3
    s_lshr_b32 s3, vcc_hi, 16
    s_cbranch_scc1 L_skR3
    v_mfma_f32_16x16x32_bf16 v[80:83], v[144:147], v[204:207], v[80:83]
    v_mfma_f32_16x16x32_bf16 v[84:87], v[148:151], v[204:207], v[84:87]
    v_mfma_f32_16x16x32_bf16 v[88:91], v[152:155], v[204:207], v[88:91]
    v_mfma_f32_16x16x32_bf16 v[92:95], v[156:159], v[204:207], v[92:95]
    s_add_u32 s27, s27, 1
L_skR3:
    s_cmp_lg_u32 s27, 4
    s_cbranch_scc1 L_skR4
    s_waitcnt vmcnt(4)
    v_cmp_ne_u32 vcc, v211, v253
    s_nop 3
    s_lshr_b32 s3, vcc_hi, 16
    s_cbranch_scc1 L_skR4
    v_mfma_f32_16x16x32_bf16 v[64:67], v[160:163], v[208:211], v[64:67]
    v_mfma_f32_16x16x32_bf16 v[68:71], v[164:167], v[208:211], v[68:71]
    v_mfma_f32_16x16x32_bf16 v[72:75], v[168:171], v[208:211], v[72:75]
    v_mfma_f32_16x16x32_bf16 v[76:79], v[172:175], v[208:211], v[76:79]
    s_add_u32 s27, s27, 1
L_skR4:
    s_cmp_lg_u32 s27, 5
    s_cbranch_scc1 L_skR5
    s_waitcnt vmcnt(3)
    v_cmp_ne_u32 vcc, v215, v253
    s_nop 3
    s_lshr_b32 s3, vcc_hi, 16
    s_cbranch_scc1 L_skR5
    v_mfma_f32_16x16x32_bf16 v[80:83], v[160:163], v[212:215], v[80:83]
    v_mfma_f32_16x16x32_bf16 v[84:87], v[164:167], v[212:215], v[84:87]
    v_mfma_f32_16x16x32_bf16 v[88:91], v[168:171], v[212:215], v[88:91]
    v_mfma_f32_16x16x32_bf16 v[92:95], v[172:175], v[212:215], v[92:95]
    s_add_u32 s27, s27, 1
L_skR5:
    s_cmp_lg_u32 s27, 6
    s_cbranch_scc1 L_skR6
    s_waitcnt vmcnt(2)
    v_cmp_ne_u32 vcc, v219, v253
    s_nop 3
    s_lshr_b32 s3, vcc_hi, 16
    s_cbranch_scc1 L_skR6
    v_mfma_f32_16x16x32_bf16 v[64:67], v[176:179], v[216:219], v[64:67]
    v_mfma_f32_16x16x32_bf16 v[68:71], v[180:183], v[216:219], v[68:71]
    v_mfma_f32_16x16x32_bf16 v[72:75], v[184:187], v[216:219], v[72:75]
    v_mfma_f32_16x16x32_bf16 v[76:79], v[188:191], v[216:219], v[76:79]
    s_add_u32 s27, s27, 1
L_skR6:
    s_cmp_lg_u32 s27, 7
    s_cbranch_scc1 L_skR7
    s_waitcnt vmcnt(1)
    v_cmp_ne_u32 vcc, v223, v253
    s_nop 3
    s_lshr_b32 s3, vcc_hi, 16
    s_cbranch_scc1 L_skR7
    v_mfma_f32_16x16x32_bf16 v[80:83], v[176:179], v[220:223], v[80:83]
    v_mfma_f32_16x16x32_bf16 v[84:87], v[180:183], v[220:223], v[84:87]
    v_mfma_f32_16x16x32_bf16 v[88:91], v[184:187], v[220:223], v[88:91]
    v_mfma_f32_16x16x32_bf16 v[92:95], v[188:191], v[220:223], v[92:95]
    s_add_u32 s27, s27, 1
L_skR7:
    s_cmp_eq_u32 s27, 8
    s_cbranch_scc1 L_doneB
L_againB:
    s_cmp_gt_u32 s27, 0
    s_cbranch_scc1 L_rlB0
    buffer_load_dwordx4 v[192:195], v233, s[52:55], s96 offen offset:0 sc1
L_rlB0:
    s_cmp_gt_u32 s27, 1
    s_cbranch_scc1 L_rlB1
    buffer_load_dwordx4 v[196:199], v233, s[52:55], s97 offen offset:0 sc1
L_rlB1:
    s_cmp_gt_u32 s27, 2
    s_cbranch_scc1 L_rlB2
    buffer_load_dwordx4 v[200:203], v233, s[52:55], s96 offen offset:1024 sc1
L_rlB2:
    s_cmp_gt_u32 s27, 3
    s_cbranch_scc1 L_rlB3
    buffer_load_dwordx4 v[204:207], v233, s[52:55], s97 offen offset:1024 sc1
L_rlB3:
    s_cmp_gt_u32 s27, 4
    s_cbranch_scc1 L_rlB4
    buffer_load_dwordx4 v[208:211], v233, s[52:55], s96 offen offset:2048 sc1
L_rlB4:
    s_cmp_gt_u32 s27, 5
    s_cbranch_scc1 L_rlB5
    buffer_load_dwordx4 v[212:215], v233, s[52:55], s97 offen offset:2048 sc1
L_rlB5:
    s_cmp_gt_u32 s27, 6
    s_cbranch_scc1 L_rlB6
    buffer_load_dwordx4 v[216:219], v233, s[52:55], s96 offen offset:3072 sc1
L_rlB6:
    s_cmp_gt_u32 s27, 7
    s_cbranch_scc1 L_rlB7
    buffer_load_dwordx4 v[220:223], v233, s[52:55], s97 offen offset:3072 sc1
L_rlB7:
    s_waitcnt vmcnt(0)
L_firstB:
    s_cmp_lg_u32 s27, 0
    s_cbranch_scc1 L_skB0
    v_cmp_ne_u32 vcc, v195, v253
    s_nop 3
    s_lshr_b32 s3, vcc_hi, 16
    s_cbranch_scc1 L_skB0
    v_mfma_f32_16x16x32_bf16 v[64:67], v[128:131], v[192:195], 0
    v_mfma_f32_16x16x32_bf16 v[68:71], v[132:135], v[192:195], 0
    v_mfma_f32_16x16x32_bf16 v[72:75], v[136:139], v[192:195], 0
    v_mfma_f32_16x16x32_bf16 v[76:79], v[140:143], v[192:195], 0
    s_add_u32 s27, s27, 1
L_skB0:
    s_cmp_lg_u32 s27, 1
    s_cbranch_scc1 L_skB1
    v_cmp_ne_u32 vcc, v199, v253
    s_nop 3
    s_lshr_b32 s3, vcc_hi, 16
    s_cbranch_scc1 L_skB1
    v_mfma_f32_16x16x32_bf16 v[80:83], v[128:131], v[196:199], 0
    v_mfma_f32_16x16x32_bf16 v[84:87], v[132:135], v[196:199], 0
    v_mfma_f32_16x16x32_bf16 v[88:91], v[136:139], v[196:199], 0
    v_mfma_f32_16x16x32_bf16 v[92:95], v[140:143], v[196:199], 0
    s_add_u32 s27, s27, 1
L_skB1:
    s_cmp_lg_u32 s27, 2
    s_cbranch_scc1 L_skB2
    v_cmp_ne_u32 vcc, v203, v253
    s_nop 3
    s_lshr_b32 s3, vcc_hi, 16
    s_cbranch_scc1 L_skB2
    v_mfma_f32_16x16x32_bf16 v[64:67], v[144:147], v[200:203], v[64:67]
    v_mfma_f32_16x16x32_bf16 v[68:71], v[148:151], v[200:203], v[68:71]
    v_mfma_f32_16x16x32_bf16 v[72:75], v[152:155], v[200:203], v[72:75]
    v_mfma_f32_16x16x32_bf16 v[76:79], v[156:159], v[200:203], v[76:79]
    s_add_u32 s27, s27, 1
L_skB2:
    s_cmp_lg_u32 s27, 3
    s_cbranch_scc1 L_skB3
    v_cmp_ne_u32 vcc, v207, v253
    s_nop 3
    s_lshr_b32 s3, vcc_hi, 16
    s_cbranch_scc1 L_skB3
    v_mfma_f32_16x16x32_bf16 v[80:83], v[144:147], v[204:207], v[80:83]
    v_mfma_f32_16x16x32_bf16 v[84:87], v[148:151], v[204:207], v[84:87]
    v_mfma_f32_16x16x32_bf16 v[88:91], v[152:155], v[204:207], v[88:91]
    v_mfma_f32_16x16x32_bf16 v[92:95], v[156:159], v[204:207], v[92:95]
    s_add_u32 s27, s27, 1
L_skB3:
    s_cmp_lg_u32 s27, 4
    s_cbranch_scc1 L_skB4
    v_cmp_ne_u32 vcc, v211, v253
    s_nop 3
    s_lshr_b32 s3, vcc_hi, 16
    s_cbranch_scc1 L_skB4
    v_mfma_f32_16x16x32_bf16 v[64:67], v[160:163], v[208:211], v[64:67]
    v_mfma_f32_16x16x32_bf16 v[68:71], v[164:167], v[208:211], v[68:71]
    v_mfma_f32_16x16x32_bf16 v[72:75], v[168:171], v[208:211], v[72:75]
    v_mfma_f32_16x16x32_bf16 v[76:79], v[172:175], v[208:211], v[76:79]
    s_add_u32 s27, s27, 1
L_skB4:
    s_cmp_lg_u32 s27, 5
    s_cbranch_scc1 L_skB5
    v_cmp_ne_u32 vcc, v215, v253
    s_nop 3
    s_lshr_b32 s3, vcc_hi, 16
    s_cbranch_scc1 L_skB5
    v_mfma_f32_16x16x32_bf16 v[80:83], v[160:163], v[212:215], v[80:83]
    v_mfma_f32_16x16x32_bf16 v[84:87], v[164:167], v[212:215], v[84:87]
    v_mfma_f32_16x16x32_bf16 v[88:91], v[168:171], v[212:215], v[88:91]
    v_mfma_f32_16x16x32_bf16 v[92:95], v[172:175], v[212:215], v[92:95]
    s_add_u32 s27, s27, 1
L_skB5:
    s_cmp_lg_u32 s27, 6
    s_cbranch_scc1 L_skB6
    v_cmp_ne_u32 vcc, v219, v253
    s_nop 3
    s_lshr_b32 s3, vcc_hi, 16
    s_cbranch_scc1 L_skB6
    v_mfma_f32_16x16x32_bf16 v[64:67], v[176:179], v[216:219], v[64:67]
    v_mfma_f32_16x16x32_bf16 v[68:71], v[180:183], v[216:219], v[68:71]
    v_mfma_f32_16x16x32_bf16 v[72:75], v[184:187], v[216:219], v[72:75]
    v_mfma_f32_16x16x32_bf16 v[76:79], v[188:191], v[216:219], v[76:79]
    s_add_u32 s27, s27, 1
L_skB6:
    s_cmp_lg_u32 s27, 7
    s_cbranch_scc1 L_skB7
    v_cmp_ne_u32 vcc, v223, v253
    s_nop 3
    s_lshr_b32 s3, vcc_hi, 16
    s_cbranch_scc1 L_skB7
    v_mfma_f32_16x16x32_bf16 v[80:83], v[176:179], v[220:223], v[80:83]
    v_mfma_f32_16x16x32_bf16 v[84:87], v[180:183], v[220:223], v[84:87]
    v_mfma_f32_16x16x32_bf16 v[88:91], v[184:187], v[220:223], v[88:91]
    v_mfma_f32_16x16x32_bf16 v[92:95], v[188:191], v[220:223], v[92:95]
    s_add_u32 s27, s27, 1
L_skB7:
    s_cmp_eq_u32 s14, 0
    s_cbranch_scc1 L_doneB
    s_sub_u32 s14, s14, 1
    s_cmp_lg_u32 s27, 8
    s_cbranch_scc1 L_againB
L_doneB:
    s_mov_b32 s27, 0
    s_waitcnt lgkmcnt(0)
    v_and_b32 v2, v250, v2
    v_and_b32 v3, v250, v3
    v_and_b32 v6, v250, v6
    v_and_b32 v7, v250, v7
    v_and_b32 v10, v250, v10
    v_and_b32 v11, v250, v11
    v_and_b32 v14, v250, v14
    v_and_b32 v15, v250, v15
    v_and_b32 v18, v250, v18
    v_and_b32 v19, v250, v19
    v_and_b32 v22, v250, v22
    v_and_b32 v23, v250, v23
    v_and_b32 v26, v250, v26
    v_and_b32 v27, v250, v27
    v_and_b32 v30, v250, v30
    v_and_b32 v31, v250, v31
    v_and_b32 v34, v250, v34
    v_and_b32 v35, v250, v35
    v_and_b32 v38, v250, v38
    v_and_b32 v39, v250, v39
    v_and_b32 v42, v250, v42
    v_and_b32 v43, v250, v43
    v_and_b32 v46, v250, v46
    v_and_b32 v47, v250, v47
    v_and_b32 v50, v250, v50
    v_and_b32 v51, v250, v51
    v_and_b32 v54, v250, v54
    v_and_b32 v55, v250, v55
    v_and_b32 v58, v250, v58
    v_and_b32 v59, v250, v59
    v_and_b32 v62, v250, v62
    v_and_b32 v63, v250, v63
    s_barrier
    buffer_load_dwordx4 v[192:195], v233, s[52:55], s28 offen offset:0 sc1
    buffer_load_dwordx4 v[196:199], v233, s[52:55], s29 offen offset:0 sc1
    buffer_load_dwordx4 v[200:203], v233, s[52:55], s28 offen offset:1024 sc1
    buffer_load_dwordx4 v[204:207], v233, s[52:55], s29 offen offset:1024 sc1
    buffer_load_dwordx4 v[208:211], v233, s[52:55], s28 offen offset:2048 sc1
    buffer_load_dwordx4 v[212:215], v233, s[52:55], s29 offen offset:2048 sc1
    buffer_load_dwordx4 v[216:219], v233, s[52:55], s28 offen offset:3072 sc1
    buffer_load_dwordx4 v[220:223], v233, s[52:55], s29 offen offset:3072 sc1
    ds_write_b128 v224, v[64:67] offset:0
    ds_write_b128 v225, v[68:71] offset:0
    ds_write_b128 v226, v[72:75] offset:0
    ds_write_b128 v227, v[76:79] offset:0
    ds_write_b128 v224, v[80:83] offset:4096
    ds_write_b128 v225, v[84:87] offset:4096
    ds_write_b128 v226, v[88:91] offset:4096
    ds_write_b128 v227, v[92:95] offset:4096
    s_waitcnt lgkmcnt(0)
    s_barrier
    ds_read_b128 v[128:131], v228 offset:0
    ds_read_b128 v[132:135], v229 offset:0
    ds_read_b128 v[136:139], v228 offset:16384
    ds_read_b128 v[140:143], v229 offset:16384
    ds_read_b128 v[144:147], v228 offset:32768
    ds_read_b128 v[148:151], v229 offset:32768
    ds_read_b128 v[152:155], v228 offset:49152
    ds_read_b128 v[156:159], v229 offset:49152
    s_waitcnt lgkmcnt(4)
    v_add_f32 v128, v128, v136
    v_add_f32 v129, v129, v137
    v_add_f32 v130, v130, v138
    v_add_f32 v131, v131, v139
    v_add_f32 v132, v132, v140
    v_add_f32 v133, v133, v141
    v_add_f32 v134, v134, v142
    v_add_f32 v135, v135, v143
    s_waitcnt lgkmcnt(0)
    v_add_f32 v144, v144, v152
    v_add_f32 v145, v145, v153
    v_add_f32 v146, v146, v154
    v_add_f32 v147, v147, v155
    v_add_f32 v148, v148, v156
    v_add_f32 v149, v149, v157
    v_add_f32 v150, v150, v158
    v_add_f32 v151, v151, v159
    v_add_f32 v128, v128, v144
    v_add_f32 v129, v129, v145
    v_add_f32 v130, v130, v146
    v_add_f32 v131, v131, v147
    v_add_f32 v132, v132, v148
    v_add_f32 v133, v133, v149
    v_add_f32 v134, v134, v150
    v_add_f32 v135, v135, v151
    v_cvt_pk_bf16_f32 v136, v128, v129
    v_cvt_pk_bf16_f32 v137, v130, v131
    v_cvt_pk_bf16_f32 v138, v132, v133
    v_cvt_pk_bf16_f32 v139, v134, v135
    s_mov_b32 s3, 896
    buffer_store_dwordx4 v[136:139], v230, s[56:59], s3 offen
    v_add_u32 v224, 65536, v224
    v_add_u32 v225, 65536, v225
    v_add_u32 v226, 65536, v226
    v_add_u32 v227, 65536, v227
    v_add_u32 v228, 65536, v228
    v_add_u32 v229, 65536, v229
    s_cmp_lg_u32 s27, 0
    s_cbranch_scc1 L_skQ0
    s_waitcnt vmcnt(8)
    v_cmp_ne_u32 vcc, v195, v253
    s_nop 3
    s_lshr_b32 s3, vcc_hi, 16
    s_cbranch_scc1 L_skQ0
    v_mfma_f32_16x16x32_bf16 v[96:99], v[0:3], v[192:195], 0
    v_mfma_f32_16x16x32_bf16 v[100:103], v[4:7], v[192:195], 0
    v_mfma_f32_16x16x32_bf16 v[104:107], v[8:11], v[192:195], 0
    v_mfma_f32_16x16x32_bf16 v[108:111], v[12:15], v[192:195], 0
    s_add_u32 s27, s27, 1
L_skQ0:
    s_cmp_lg_u32 s27, 1
    s_cbranch_scc1 L_skQ1
    s_waitcnt vmcnt(7)
    v_cmp_ne_u32 vcc, v199, v253
    s_nop 3
    s_lshr_b32 s3, vcc_hi, 16
    s_cbranch_scc1 L_skQ1
    v_mfma_f32_16x16x32_bf16 v[112:115], v[0:3], v[196:199], 0
    v_mfma_f32_16x16x32_bf16 v[116:119], v[4:7], v[196:199], 0
    v_mfma_f32_16x16x32_bf16 v[120:123], v[8:11], v[196:199], 0
    v_mfma_f32_16x16x32_bf16 v[124:127], v[12:15], v[196:199], 0
    s_add_u32 s27, s27, 1
L_skQ1:
    s_cmp_lg_u32 s27, 2
    s_cbranch_scc1 L_skQ2
    s_waitcnt vmcnt(6)
    v_cmp_ne_u32 vcc, v203, v253
    s_nop 3
    s_lshr_b32 s3, vcc_hi, 16
    s_cbranch_scc1 L_skQ2
    v_mfma_f32_16x16x32_bf16 v[96:99], v[16:19], v[200:203], v[96:99]
    v_mfma_f32_16x16x32_bf16 v[100:103], v[20:23], v[200:203], v[100:103]
    v_mfma_f32_16x16x32_bf16 v[104:107], v[24:27], v[200:203], v[104:107]
    v_mfma_f32_16x16x32_bf16 v[108:111], v[28:31], v[200:203], v[108:111]
    s_add_u32 s27, s27, 1
L_skQ2:
    s_cmp_lg_u32 s27, 3
    s_cbranch_scc1 L_skQ3
    s_waitcnt vmcnt(5)
    v_cmp_ne_u32 vcc, v207, v253
    s_nop 3
    s_lshr_b32 s3, vcc_hi, 16
    s_cbranch_scc1 L_skQ3
    v_mfma_f32_16x16x32_bf16 v[112:115], v[16:19], v[204:207], v[112:115]
    v_mfma_f32_16x16x32_bf16 v[116:119], v[20:23], v[204:207], v[116:119]
    v_mfma_f32_16x16x32_bf16 v[120:123], v[24:27], v[204:207], v[120:123]
    v_mfma_f32_16x16x32_bf16 v[124:127], v[28:31], v[204:207], v[124:127]
    s_add_u32 s27, s27, 1
L_skQ3:
    s_cmp_lg_u32 s27, 4
    s_cbranch_scc1 L_skQ4
    s_waitcnt vmcnt(4)
    v_cmp_ne_u32 vcc, v211, v253
    s_nop 3
    s_lshr_b32 s3, vcc_hi, 16
    s_cbranch_scc1 L_skQ4
    v_mfma_f32_16x16x32_bf16 v[96:99], v[32:35], v[208:211], v[96:99]
    v_mfma_f32_16x16x32_bf16 v[100:103], v[36:39], v[208:211], v[100:103]
    v_mfma_f32_16x16x32_bf16 v[104:107], v[40:43], v[208:211], v[104:107]
    v_mfma_f32_16x16x32_bf16 v[108:111], v[44:47], v[208:211], v[108:111]
    s_add_u32 s27, s27, 1
L_skQ4:
    s_cmp_lg_u32 s27, 5
    s_cbranch_scc1 L_skQ5
    s_waitcnt vmcnt(3)
    v_cmp_ne_u32 vcc, v215, v253
    s_nop 3
    s_lshr_b32 s3, vcc_hi, 16
    s_cbranch_scc1 L_skQ5
    v_mfma_f32_16x16x32_bf16 v[112:115], v[32:35], v[212:215], v[112:115]
    v_mfma_f32_16x16x32_bf16 v[116:119], v[36:39], v[212:215], v[116:119]
    v_mfma_f32_16x16x32_bf16 v[120:123], v[40:43], v[212:215], v[120:123]
    v_mfma_f32_16x16x32_bf16 v[124:127], v[44:47], v[212:215], v[124:127]
    s_add_u32 s27, s27, 1
L_skQ5:
    s_cmp_lg_u32 s27, 6
    s_cbranch_scc1 L_skQ6
    s_waitcnt vmcnt(2)
    v_cmp_ne_u32 vcc, v219, v253
    s_nop 3
    s_lshr_b32 s3, vcc_hi, 16
    s_cbranch_scc1 L_skQ6
    v_mfma_f32_16x16x32_bf16 v[96:99], v[48:51], v[216:219], v[96:99]
    v_mfma_f32_16x16x32_bf16 v[100:103], v[52:55], v[216:219], v[100:103]
    v_mfma_f32_16x16x32_bf16 v[104:107], v[56:59], v[216:219], v[104:107]
    v_mfma_f32_16x16x32_bf16 v[108:111], v[60:63], v[216:219], v[108:111]
    s_add_u32 s27, s27, 1
L_skQ6:
    s_cmp_lg_u32 s27, 7
    s_cbranch_scc1 L_skQ7
    s_waitcnt vmcnt(1)
    v_cmp_ne_u32 vcc, v223, v253
    s_nop 3
    s_lshr_b32 s3, vcc_hi, 16
    s_cbranch_scc1 L_skQ7
    v_mfma_f32_16x16x32_bf16 v[112:115], v[48:51], v[220:223], v[112:115]
    v_mfma_f32_16x16x32_bf16 v[116:119], v[52:55], v[220:223], v[116:119]
    v_mfma_f32_16x16x32_bf16 v[120:123], v[56:59], v[220:223], v[120:123]
    v_mfma_f32_16x16x32_bf16 v[124:127], v[60:63], v[220:223], v[124:127]
    s_add_u32 s27, s27, 1
L_skQ7:
    s_cmp_eq_u32 s27, 8
    s_cbranch_scc1 L_doneA
L_againA:
    s_cmp_gt_u32 s27, 0
    s_cbranch_scc1 L_rlA0
    buffer_load_dwordx4 v[192:195], v233, s[52:55], s28 offen offset:0 sc1
L_rlA0:
    s_cmp_gt_u32 s27, 1
    s_cbranch_scc1 L_rlA1
    buffer_load_dwordx4 v[196:199], v233, s[52:55], s29 offen offset:0 sc1
L_rlA1:
    s_cmp_gt_u32 s27, 2
    s_cbranch_scc1 L_rlA2
    buffer_load_dwordx4 v[200:203], v233, s[52:55], s28 offen offset:1024 sc1
L_rlA2:
    s_cmp_gt_u32 s27, 3
    s_cbranch_scc1 L_rlA3
    buffer_load_dwordx4 v[204:207], v233, s[52:55], s29 offen offset:1024 sc1
L_rlA3:
    s_cmp_gt_u32 s27, 4
    s_cbranch_scc1 L_rlA4
    buffer_load_dwordx4 v[208:211], v233, s[52:55], s28 offen offset:2048 sc1
L_rlA4:
    s_cmp_gt_u32 s27, 5
    s_cbranch_scc1 L_rlA5
    buffer_load_dwordx4 v[212:215], v233, s[52:55], s29 offen offset:2048 sc1
L_rlA5:
    s_cmp_gt_u32 s27, 6
    s_cbranch_scc1 L_rlA6
    buffer_load_dwordx4 v[216:219], v233, s[52:55], s28 offen offset:3072 sc1
L_rlA6:
    s_cmp_gt_u32 s27, 7
    s_cbranch_scc1 L_rlA7
    buffer_load_dwordx4 v[220:223], v233, s[52:55], s29 offen offset:3072 sc1
L_rlA7:
    s_waitcnt vmcnt(0)
L_firstA:
    s_cmp_lg_u32 s27, 0
    s_cbranch_scc1 L_skA0
    v_cmp_ne_u32 vcc, v195, v253
    s_nop 3
    s_lshr_b32 s3, vcc_hi, 16
    s_cbranch_scc1 L_skA0
    v_mfma_f32_16x16x32_bf16 v[96:99], v[0:3], v[192:195], 0
    v_mfma_f32_16x16x32_bf16 v[100:103], v[4:7], v[192:195], 0
    v_mfma_f32_16x16x32_bf16 v[104:107], v[8:11], v[192:195], 0
    v_mfma_f32_16x16x32_bf16 v[108:111], v[12:15], v[192:195], 0
    s_add_u32 s27, s27, 1
L_skA0:
    s_cmp_lg_u32 s27, 1
    s_cbranch_scc1 L_skA1
    v_cmp_ne_u32 vcc, v199, v253
    s_nop 3
    s_lshr_b32 s3, vcc_hi, 16
    s_cbranch_scc1 L_skA1
    v_mfma_f32_16x16x32_bf16 v[112:115], v[0:3], v[196:199], 0
    v_mfma_f32_16x16x32_bf16 v[116:119], v[4:7], v[196:199], 0
    v_mfma_f32_16x16x32_bf16 v[120:123], v[8:11], v[196:199], 0
    v_mfma_f32_16x16x32_bf16 v[124:127], v[12:15], v[196:199], 0
    s_add_u32 s27, s27, 1
L_skA1:
    s_cmp_lg_u32 s27, 2
    s_cbranch_scc1 L_skA2
    v_cmp_ne_u32 vcc, v203, v253
    s_nop 3
    s_lshr_b32 s3, vcc_hi, 16
    s_cbranch_scc1 L_skA2
    v_mfma_f32_16x16x32_bf16 v[96:99], v[16:19], v[200:203], v[96:99]
    v_mfma_f32_16x16x32_bf16 v[100:103], v[20:23], v[200:203], v[100:103]
    v_mfma_f32_16x16x32_bf16 v[104:107], v[24:27], v[200:203], v[104:107]
    v_mfma_f32_16x16x32_bf16 v[108:111], v[28:31], v[200:203], v[108:111]
    s_add_u32 s27, s27, 1
L_skA2:
    s_cmp_lg_u32 s27, 3
    s_cbranch_scc1 L_skA3
    v_cmp_ne_u32 vcc, v207, v253
    s_nop 3
    s_lshr_b32 s3, vcc_hi, 16
    s_cbranch_scc1 L_skA3
    v_mfma_f32_16x16x32_bf16 v[112:115], v[16:19], v[204:207], v[112:115]
    v_mfma_f32_16x16x32_bf16 v[116:119], v[20:23], v[204:207], v[116:119]
    v_mfma_f32_16x16x32_bf16 v[120:123], v[24:27], v[204:207], v[120:123]
    v_mfma_f32_16x16x32_bf16 v[124:127], v[28:31], v[204:207], v[124:127]
    s_add_u32 s27, s27, 1
L_skA3:
    s_cmp_lg_u32 s27, 4
    s_cbranch_scc1 L_skA4
    v_cmp_ne_u32 vcc, v211, v253
    s_nop 3
    s_lshr_b32 s3, vcc_hi, 16
    s_cbranch_scc1 L_skA4
    v_mfma_f32_16x16x32_bf16 v[96:99], v[32:35], v[208:211], v[96:99]
    v_mfma_f32_16x16x32_bf16 v[100:103], v[36:39], v[208:211], v[100:103]
    v_mfma_f32_16x16x32_bf16 v[104:107], v[40:43], v[208:211], v[104:107]
    v_mfma_f32_16x16x32_bf16 v[108:111], v[44:47], v[208:211], v[108:111]
    s_add_u32 s27, s27, 1
L_skA4:
    s_cmp_lg_u32 s27, 5
    s_cbranch_scc1 L_skA5
    v_cmp_ne_u32 vcc, v215, v253
    s_nop 3
    s_lshr_b32 s3, vcc_hi, 16
    s_cbranch_scc1 L_skA5
    v_mfma_f32_16x16x32_bf16 v[112:115], v[32:35], v[212:215], v[112:115]
    v_mfma_f32_16x16x32_bf16 v[116:119], v[36:39], v[212:215], v[116:119]
    v_mfma_f32_16x16x32_bf16 v[120:123], v[40:43], v[212:215], v[120:123]
    v_mfma_f32_16x16x32_bf16 v[124:127], v[44:47], v[212:215], v[124:127]
    s_add_u32 s27, s27, 1
L_skA5:
    s_cmp_lg_u32 s27, 6
    s_cbranch_scc1 L_skA6
    v_cmp_ne_u32 vcc, v219, v253
    s_nop 3
    s_lshr_b32 s3, vcc_hi, 16
    s_cbranch_scc1 L_skA6
    v_mfma_f32_16x16x32_bf16 v[96:99], v[48:51], v[216:219], v[96:99]
    v_mfma_f32_16x16x32_bf16 v[100:103], v[52:55], v[216:219], v[100:103]
    v_mfma_f32_16x16x32_bf16 v[104:107], v[56:59], v[216:219], v[104:107]
    v_mfma_f32_16x16x32_bf16 v[108:111], v[60:63], v[216:219], v[108:111]
    s_add_u32 s27, s27, 1
L_skA6:
    s_cmp_lg_u32 s27, 7
    s_cbranch_scc1 L_skA7
    v_cmp_ne_u32 vcc, v223, v253
    s_nop 3
    s_lshr_b32 s3, vcc_hi, 16
    s_cbranch_scc1 L_skA7
    v_mfma_f32_16x16x32_bf16 v[112:115], v[48:51], v[220:223], v[112:115]
    v_mfma_f32_16x16x32_bf16 v[116:119], v[52:55], v[220:223], v[116:119]
    v_mfma_f32_16x16x32_bf16 v[120:123], v[56:59], v[220:223], v[120:123]
    v_mfma_f32_16x16x32_bf16 v[124:127], v[60:63], v[220:223], v[124:127]
    s_add_u32 s27, s27, 1
L_skA7:
    s_cmp_eq_u32 s14, 0
    s_cbranch_scc1 L_doneA
    s_sub_u32 s14, s14, 1
    s_cmp_lg_u32 s27, 8
    s_cbranch_scc1 L_againA
L_doneA:
    ds_write_b128 v224, v[96:99] offset:0
    ds_write_b128 v225, v[100:103] offset:0
    ds_write_b128 v226, v[104:107] offset:0
    ds_write_b128 v227, v[108:111] offset:0
    ds_write_b128 v224, v[112:115] offset:4096
    ds_write_b128 v225, v[116:119] offset:4096
    ds_write_b128 v226, v[120:123] offset:4096
    ds_write_b128 v227, v[124:127] offset:4096
    s_waitcnt lgkmcnt(0)
    s_barrier
    ds_read_b128 v[160:163], v228 offset:0
    ds_read_b128 v[164:167], v229 offset:0
    ds_read_b128 v[168:171], v228 offset:16384
    ds_read_b128 v[172:175], v229 offset:16384
    ds_read_b128 v[176:179], v228 offset:32768
    ds_read_b128 v[180:183], v229 offset:32768
    ds_read_b128 v[184:187], v228 offset:49152
    ds_read_b128 v[188:191], v229 offset:49152
    s_waitcnt lgkmcnt(4)
    v_add_f32 v160, v160, v168
    v_add_f32 v161, v161, v169
    v_add_f32 v162, v162, v170
    v_add_f32 v163, v163, v171
    v_add_f32 v164, v164, v172
    v_add_f32 v165, v165, v173
    v_add_f32 v166, v166, v174
    v_add_f32 v167, v167, v175
    s_waitcnt lgkmcnt(0)
    v_add_f32 v176, v176, v184
    v_add_f32 v177, v177, v185
    v_add_f32 v178, v178, v186
    v_add_f32 v179, v179, v187
    v_add_f32 v180, v180, v188
    v_add_f32 v181, v181, v189
    v_add_f32 v182, v182, v190
    v_add_f32 v183, v183, v191
    v_add_f32 v160, v160, v176
    v_add_f32 v161, v161, v177
    v_add_f32 v162, v162, v178
    v_add_f32 v163, v163, v179
    v_add_f32 v164, v164, v180
    v_add_f32 v165, v165, v181
    v_add_f32 v166, v166, v182
    v_add_f32 v167, v167, v183
    v_cvt_pk_bf16_f32 v168, v160, v161
    v_cvt_pk_bf16_f32 v169, v162, v163
    v_cvt_pk_bf16_f32 v170, v164, v165
    v_cvt_pk_bf16_f32 v171, v166, v167
    s_mov_b32 s3, 0
    buffer_store_dwordx4 v[168:171], v230, s[56:59], s3 offen
L_fin:
L_end:
    s_endpgm
.section .rodata,"a"
.p2align 6
.amdhsa_kernel concat_heads__sliding_block__sliding_local_dilated__prompt_kernel
  .amdhsa_next_free_vgpr 256
  .amdhsa_next_free_sgpr 102
  .amdhsa_accum_offset 256
  .amdhsa_group_segment_fixed_size 0
  .amdhsa_kernarg_size 72
  .amdhsa_user_sgpr_count 2
  .amdhsa_user_sgpr_kernarg_segment_ptr 1
  .amdhsa_system_sgpr_workgroup_id_x 1
.end_amdhsa_kernel
```
